```python
import torch

def _softmax(x, axis=-1):
    return torch.softmax(x, dim=axis)
def _gelu(x):
    return torch.nn.functional.gelu(x, approximate="tanh")
def _silu(x):
    return torch.nn.functional.silu(x)
def _sigmoid(x):
    return torch.sigmoid(x)
def _layernorm(x, axis=-1, eps=1e-5):
    m = x.mean(dim=axis, keepdim=True)
    v = x.var(dim=axis, keepdim=True, unbiased=False)
    return (x - m) / torch.sqrt(v + eps)
def _scatter_add(tgt, idx, src, axis=0):
    return tgt.clone().index_add_(axis, idx, src)
def _segment_sum(src, seg, n):
    out = torch.zeros((n,) + src.shape[1:], dtype=src.dtype)
    return out.index_add_(0, seg, src)
def _pad(x, pw):
    flat = tuple(v for pair in reversed(pw) for v in pair)
    return torch.nn.functional.pad(x, flat)

kernel_name = 'interleave_layers__mha_block__mixer_token_mlp__prompt'

def setup_inputs():

    _w = (lambda a: (lambda t: t.to(torch.bfloat16) if t.is_floating_point() else t)(torch.as_tensor(a)))
    def _A_setup():
        B, S, D, H = 1, 2048, 640, 32
        return {
            "x": _w((lambda *s: torch.randn(*s, dtype=torch.bfloat16) * 0.05)(B, S, D)),
            "wqkv": _w((lambda *s: torch.randn(*s, dtype=torch.bfloat16) * 0.05)(D, 3 * D)),
            "wo": _w((lambda *s: torch.randn(*s, dtype=torch.bfloat16) * 0.05)(D, D)),
        }
    _A_in = _A_setup()

    def _B_setup():
        B, S, D, F = 1, 2048, 640, 1536
        return {
            "x": _w((lambda *s: torch.randn(*s, dtype=torch.bfloat16) * 0.05)(B, S, D)),
            "w1": _w((lambda *s: torch.randn(*s, dtype=torch.bfloat16) * 0.8)(S, F) * (S ** -0.5)),
            "b1": _w((lambda *s: torch.randn(*s, dtype=torch.bfloat16) * 12.8)(F) * 0.02),
            "w2": _w((lambda *s: torch.randn(*s, dtype=torch.bfloat16) * 0.4)(F, S) * (F ** -0.5)),
            "b2": _w((lambda *s: torch.randn(*s, dtype=torch.bfloat16) * 6.4)(S) * 0.02),
        }
    _B_in = _B_setup()

    return {
        "A_x": _A_in["x"],
        "A_wqkv": _A_in["wqkv"],
        "A_wo": _A_in["wo"],
        "B_x": _B_in["x"],
        "B_w1": _B_in["w1"],
        "B_b1": _B_in["b1"],
        "B_w2": _B_in["w2"],
        "B_b2": _B_in["b2"],
    }

def reference(A_x, A_wqkv, A_wo, B_x, B_w1, B_b1, B_w2, B_b2):
    def _A_ref(x, wqkv, wo):
        B, S, D = x.shape
        H = 32
        Dh = D // H
        qkv = (lambda x, *d: x.permute(*d))((x @ wqkv).reshape(B, S, 3, H, Dh), 2, 0, 3, 1, 4)
        q, k, v = qkv[0], qkv[1], qkv[2]
        scores = torch.einsum("bhqd,bhkd->bhqk", q, k) * (Dh ** -0.5)
        p = _softmax(scores, axis=-1)
        o = torch.einsum("bhqk,bhkd->bhqd", p, v)
        return (lambda x, *d: x.permute(*d))(o, 0, 2, 1, 3).reshape(B, S, D) @ wo

    def _B_ref(x, w1, b1, w2, b2):
        B, S, D = x.shape
        h = _layernorm(x, axis=-1)
        u = torch.einsum("bsd,sf->bdf", h, w1) + b1
        u = _gelu(u)
        y = torch.einsum("bdf,fs->bds", u, w2) + b2
        return (lambda x, *d: x.permute(*d))(y, 0, 2, 1)

    x = A_x
    x = x + _A_ref(_layernorm(x, axis=-1), A_wqkv, A_wo)
    x = x + _B_ref(_layernorm(x, axis=-1), B_w1, B_b1, B_w2, B_b2)
    x = x + _A_ref(_layernorm(x, axis=-1), A_wqkv, A_wo)
    x = x + _B_ref(_layernorm(x, axis=-1), B_w1, B_b1, B_w2, B_b2)
    return x
```

```asm
; @launch kernel=qkv0_kernel grid=(256,1,1) block=(768,1,1) lds=133120
; @launch kernel=mega_kernel grid=(256,1,1) block=(512,1,1) lds=163840
.amdgcn_target "amdgcn-amd-amdhsa--gfx950"
.text
.globl qkv0_kernel
.p2align 8
.type qkv0_kernel,@function
qkv0_kernel:
    s_load_dwordx2 s[4:5], s[0:1], 0
    s_load_dwordx2 s[6:7], s[0:1], 8
    s_load_dwordx2 s[8:9], s[0:1], 80
    s_movk_i32 s41, 1280
    s_movk_i32 s42, 128
    s_cmp_ge_u32 s2, 256
    s_cbranch_scc1 qkv_end
    v_lshrrev_b32 v1, 6, v0
    v_and_b32 v2, 63, v0
    v_readfirstlane_b32 s26, v1
    s_and_b32 s29, s2, 7
    s_lshr_b32 s30, s2, 3
    s_lshr_b32 s24, s29, 1
    s_lshl_b32 s24, s24, 2
    s_and_b32 s31, s30, 3
    s_add_u32 s24, s24, s31
    s_and_b32 s25, s29, 1
    s_lshl_b32 s25, s25, 3
    s_lshr_b32 s31, s30, 2
    s_add_u32 s25, s25, s31
    s_waitcnt lgkmcnt(0)
    s_mov_b32 s44, s4
    s_mov_b32 s45, s5
    s_mov_b32 s46, 2621440
    s_mov_b32 s47, 0x20000
    s_mov_b32 s16, s6
    s_mov_b32 s17, s7
    s_mov_b32 s18, 2457600
    s_mov_b32 s19, 0x20000
    s_mov_b32 s20, s8
    s_mov_b32 s21, s9
    s_mov_b32 s22, 18833408
    s_mov_b32 s23, 0x20000
    s_cmp_ge_u32 s25, 15
    s_cbranch_scc1 qkv_repack
    s_cmp_lt_u32 s26, 4
    s_cbranch_scc1 qkv_cmp
    s_cmp_ge_u32 s26, 8
    s_cbranch_scc1 qkv_stat
    s_sub_u32 s26, s26, 4
    v_lshrrev_b32 v7, 3, v2
    s_lshl_b32 s31, s24, 7
    s_lshl_b32 s32, s26, 5
    s_add_u32 s31, s31, s32
    v_add_u32 v7, s31, v7
    v_mul_u32_u24 v7, s41, v7
    s_lshl_b32 s41, s41, 3
    s_lshl_b32 s43, s41, 1
    s_add_u32 s48, s43, s41
    v_and_b32 v8, 7, v2
    v_lshrrev_b32 v9, 4, v2
    v_xor_b32 v8, v8, v9
    v_lshl_add_u32 v4, v8, 4, v7
    v_xor_b32 v5, 64, v4
    s_lshl_b32 s31, s26, 4
    v_add_u32 v7, s31, v9
    v_mul_u32_u24 v7, 3840, v7
    v_and_b32 v8, 15, v2
    v_lshlrev_b32 v10, 2, v9
    v_xor_b32 v8, v8, v10
    v_lshl_add_u32 v6, v8, 4, v7
    s_lshl_b32 s50, s26, 12
    s_mov_b32 s33, 0
    s_lshl_b32 s34, s25, 8
    s_add_u32 s51, s50, 131072
    s_mov_b32 s53, 0
qkv_ld0:
    s_add_u32 m0, s50, 0
    s_add_u32 s35, s33, 0
    buffer_load_dwordx4 v4, s[44:47], s35 offen lds
    s_add_u32 m0, s50, 1024
    s_add_u32 s35, s33, s41
    buffer_load_dwordx4 v5, s[44:47], s35 offen lds
    s_add_u32 m0, s50, 2048
    s_add_u32 s35, s33, s43
    buffer_load_dwordx4 v4, s[44:47], s35 offen lds
    s_add_u32 m0, s50, 3072
    s_add_u32 s35, s33, s48
    buffer_load_dwordx4 v5, s[44:47], s35 offen lds
    s_add_u32 m0, s50, 16384
    s_add_u32 s35, s34, 0
    buffer_load_dwordx4 v6, s[16:19], s35 offen lds
    s_add_u32 m0, s50, 17408
    s_add_u32 s35, s34, 15360
    buffer_load_dwordx4 v6, s[16:19], s35 offen lds
    s_add_u32 m0, s50, 18432
    s_add_u32 s35, s34, 30720
    buffer_load_dwordx4 v6, s[16:19], s35 offen lds
    s_add_u32 m0, s50, 19456
    s_add_u32 s35, s34, 46080
    buffer_load_dwordx4 v6, s[16:19], s35 offen lds
    s_add_u32 s33, s33, s42
    s_add_u32 s34, s34, 245760
    s_add_u32 s50, s50, 32768
    s_cmp_eq_u32 s50, s51
    s_cselect_b32 s52, 131072, 0
    s_sub_u32 s50, s50, s52
    s_add_u32 s53, s53, 1
    s_cmp_lg_u32 s53, 2
    s_cbranch_scc1 qkv_ld1
    s_waitcnt vmcnt(8)
    s_barrier
qkv_ld1:
    s_cmp_lt_u32 s53, 4
    s_cbranch_scc1 qkv_ld0
    s_mov_b32 s53, 6
qkv_ld2:
    s_waitcnt vmcnt(16)
    s_barrier
    s_add_u32 m0, s50, 0
    s_add_u32 s35, s33, 0
    buffer_load_dwordx4 v4, s[44:47], s35 offen lds
    s_add_u32 m0, s50, 1024
    s_add_u32 s35, s33, s41
    buffer_load_dwordx4 v5, s[44:47], s35 offen lds
    s_add_u32 m0, s50, 2048
    s_add_u32 s35, s33, s43
    buffer_load_dwordx4 v4, s[44:47], s35 offen lds
    s_add_u32 m0, s50, 3072
    s_add_u32 s35, s33, s48
    buffer_load_dwordx4 v5, s[44:47], s35 offen lds
    s_add_u32 m0, s50, 16384
    s_add_u32 s35, s34, 0
    buffer_load_dwordx4 v6, s[16:19], s35 offen lds
    s_add_u32 m0, s50, 17408
    s_add_u32 s35, s34, 15360
    buffer_load_dwordx4 v6, s[16:19], s35 offen lds
    s_add_u32 m0, s50, 18432
    s_add_u32 s35, s34, 30720
    buffer_load_dwordx4 v6, s[16:19], s35 offen lds
    s_add_u32 m0, s50, 19456
    s_add_u32 s35, s34, 46080
    buffer_load_dwordx4 v6, s[16:19], s35 offen lds
    s_add_u32 s33, s33, s42
    s_add_u32 s34, s34, 245760
    s_add_u32 s50, s50, 32768
    s_cmp_eq_u32 s50, s51
    s_cselect_b32 s52, 131072, 0
    s_sub_u32 s50, s50, s52
    s_sub_u32 s53, s53, 1
    s_cmp_lg_u32 s53, 0
    s_cbranch_scc1 qkv_ld2
    s_waitcnt vmcnt(16)
    s_barrier
    s_waitcnt vmcnt(8)
    s_barrier
    s_waitcnt vmcnt(0)
    s_barrier
    s_waitcnt vmcnt(0)
    s_barrier
    v_lshlrev_b32 v3, 2, v0
    v_subrev_u32 v3, 1024, v3
    v_mov_b32 v4, 0
    s_lshl_b32 s31, s24, 4
    s_add_u32 s31, s31, s25
    s_lshl_b32 s31, s31, 10
    s_add_u32 s31, s31, 18546688
    buffer_store_dword v4, v3, s[20:23], s31 offen
    s_cmp_lg_u32 s25, 14
    s_cbranch_scc1 qkv_z1
    buffer_store_dword v4, v3, s[20:23], s31 offen offset:1024
qkv_z1:
    s_cmp_ge_u32 s2, 48
    s_cbranch_scc1 qkv_end
    s_lshl_b32 s31, s2, 10
    s_cmp_ge_u32 s2, 32
    s_cselect_b32 s32, 1081344, 0
    s_add_u32 s31, s31, s32
    s_add_u32 s31, s31, 17694720
    buffer_store_dword v4, v3, s[20:23], s31 offen
    s_endpgm
qkv_cmp:
    s_lshr_b32 s27, s26, 1
    s_and_b32 s28, s26, 1
    v_and_b32 v18, 31, v2
    v_lshrrev_b32 v19, 5, v2
    v_lshrrev_b32 v20, 1, v18
    v_and_b32 v20, 7, v20
    v_xor_b32 v20, v20, v19
    v_lshlrev_b32 v20, 4, v20
    v_lshl_add_u32 v20, v18, 7, v20
    s_lshl_b32 s31, s27, 13
    s_lshl_b32 s32, s28, 12
    s_add_u32 s31, s31, s32
    v_add_u32 v8, s31, v20
    v_xor_b32 v12, 0x1000, v8
    v_xor_b32 v9, 32, v8
    v_xor_b32 v13, 32, v12
    v_xor_b32 v10, 64, v8
    v_xor_b32 v14, 64, v12
    v_xor_b32 v11, 96, v8
    v_xor_b32 v15, 96, v12
    v_and_b32 v20, 15, v2
    v_lshrrev_b32 v21, 2, v20
    v_lshl_add_u32 v22, v19, 3, v21
    v_lshlrev_b32 v22, 8, v22
    s_lshl_b32 s31, s28, 1
    s_add_u32 s31, s31, s27
    v_xor_b32 v21, s31, v21
    v_lshl_add_u32 v22, v21, 6, v22
    v_and_b32 v21, 16, v2
    v_lshl_add_u32 v22, v21, 1, v22
    v_and_b32 v21, 3, v2
    v_lshl_add_u32 v22, v21, 3, v22
    v_add_u32 v16, 16384, v22
    v_xor_b32 v17, 64, v16
    v_mov_b32 v25, 0
    v_lshrrev_b32 v20, 2, v2
    v_lshrrev_b32 v21, 4, v2
    v_xor_b32 v20, v20, v21
    v_and_b32 v20, 1, v20
    v_cmp_eq_u32 vcc, 0, v20
    v_mov_b32 v21, 0x3f803f80
    s_nop 0
    v_cndmask_b32 v140, 0, v21, vcc
    v_cndmask_b32 v141, 0, v21, vcc
    v_cndmask_b32 v142, 0, v21, vcc
    v_cndmask_b32 v143, 0, v21, vcc
    s_mov_b32 s36, 0xffff0000
    v_mov_b32 v144, 0
    v_mov_b32 v145, 0
    v_mov_b32 v146, 0
    v_mov_b32 v147, 0
    v_mov_b32 v148, 0
    v_mov_b32 v149, 0
    v_mov_b32 v150, 0
    v_mov_b32 v151, 0
    v_mov_b32 v64, 0
    v_mov_b32 v65, 0
    v_mov_b32 v66, 0
    v_mov_b32 v67, 0
    v_mov_b32 v68, 0
    v_mov_b32 v69, 0
    v_mov_b32 v70, 0
    v_mov_b32 v71, 0
    v_mov_b32 v72, 0
    v_mov_b32 v73, 0
    v_mov_b32 v74, 0
    v_mov_b32 v75, 0
    v_mov_b32 v76, 0
    v_mov_b32 v77, 0
    v_mov_b32 v78, 0
    v_mov_b32 v79, 0
    v_mov_b32 v80, 0
    v_mov_b32 v81, 0
    v_mov_b32 v82, 0
    v_mov_b32 v83, 0
    v_mov_b32 v84, 0
    v_mov_b32 v85, 0
    v_mov_b32 v86, 0
    v_mov_b32 v87, 0
    v_mov_b32 v88, 0
    v_mov_b32 v89, 0
    v_mov_b32 v90, 0
    v_mov_b32 v91, 0
    v_mov_b32 v92, 0
    v_mov_b32 v93, 0
    v_mov_b32 v94, 0
    v_mov_b32 v95, 0
    v_mov_b32 v96, 0
    v_mov_b32 v97, 0
    v_mov_b32 v98, 0
    v_mov_b32 v99, 0
    v_mov_b32 v100, 0
    v_mov_b32 v101, 0
    v_mov_b32 v102, 0
    v_mov_b32 v103, 0
    v_mov_b32 v104, 0
    v_mov_b32 v105, 0
    v_mov_b32 v106, 0
    v_mov_b32 v107, 0
    v_mov_b32 v108, 0
    v_mov_b32 v109, 0
    v_mov_b32 v110, 0
    v_mov_b32 v111, 0
    v_mov_b32 v112, 0
    v_mov_b32 v113, 0
    v_mov_b32 v114, 0
    v_mov_b32 v115, 0
    v_mov_b32 v116, 0
    v_mov_b32 v117, 0
    v_mov_b32 v118, 0
    v_mov_b32 v119, 0
    v_mov_b32 v120, 0
    v_mov_b32 v121, 0
    v_mov_b32 v122, 0
    v_mov_b32 v123, 0
    v_mov_b32 v124, 0
    v_mov_b32 v125, 0
    v_mov_b32 v126, 0
    v_mov_b32 v127, 0
    v_mov_b32 v128, v8
    v_mov_b32 v129, v9
    v_mov_b32 v130, v10
    v_mov_b32 v131, v11
    v_mov_b32 v132, v12
    v_mov_b32 v133, v13
    v_mov_b32 v134, v14
    v_mov_b32 v135, v15
    v_mov_b32 v136, v16
    v_mov_b32 v137, v17
    s_lshr_b32 s38, s24, 1
    s_and_b32 s39, s24, 1
    s_lshl_b32 s39, s39, 2
    s_lshl_b32 s31, s27, 1
    s_add_u32 s39, s39, s31
    s_cmp_lt_u32 s25, 5
    s_mov_b32 s41, 163840
    s_cselect_b32 s41, 81920, s41
    s_movk_i32 s42, 20480
    s_cselect_b32 s42, 10240, s42
    s_cselect_b32 s43, 0, 2621440
    s_cselect_b32 s44, 0, 5
    s_sub_u32 s44, s25, s44
    s_mul_i32 s42, s42, s38
    s_add_u32 s43, s43, s42
    s_add_u32 s39, s39, s28
    s_xor_b32 s45, s39, 1
    s_lshl_b32 s31, s44, 5
    s_lshl_b32 s32, s28, 4
    s_add_u32 s31, s31, s32
    s_lshl_b32 s32, s27, 3
    s_add_u32 s46, s31, s32
    s_xor_b32 s47, s46, 8
    s_movk_i32 s48, 1024
    v_lshlrev_b32 v48, 3, v18
    v_lshlrev_b32 v49, 3, v18
    v_add_u32 v49, 8192, v49
    v_add_u32 v40, s46, v19
    v_add_u32 v40, 0, v40
    v_mul_u32_u24 v41, 52429, v40
    v_lshrrev_b32 v41, 18, v41
    v_mul_u32_u24 v42, 5, v41
    v_sub_u32 v42, v40, v42
    v_mul_lo_u32 v41, v41, s41
    v_lshrrev_b32 v43, 1, v42
    v_lshl_add_u32 v43, v43, 8, v48
    v_and_b32 v44, 1, v42
    v_lshl_add_u32 v43, v44, 9, v43
    v_cmp_gt_u32 vcc, 4, v42
    v_mov_b32 v45, 256
    v_mov_b32 v46, s48
    v_cndmask_b32 v43, v49, v43, vcc
    v_cndmask_b32 v45, v45, v46, vcc
    v_add_u32 v41, v41, v43
    v_mad_u32_u24 v152, v45, s39, v41
    v_mad_u32_u24 v153, v45, s45, v41
    v_add_u32 v40, s46, v19
    v_add_u32 v40, 2, v40
    v_mul_u32_u24 v41, 52429, v40
    v_lshrrev_b32 v41, 18, v41
    v_mul_u32_u24 v42, 5, v41
    v_sub_u32 v42, v40, v42
    v_mul_lo_u32 v41, v41, s41
    v_lshrrev_b32 v43, 1, v42
    v_lshl_add_u32 v43, v43, 8, v48
    v_and_b32 v44, 1, v42
    v_lshl_add_u32 v43, v44, 9, v43
    v_cmp_gt_u32 vcc, 4, v42
    v_mov_b32 v45, 256
    v_mov_b32 v46, s48
    v_cndmask_b32 v43, v49, v43, vcc
    v_cndmask_b32 v45, v45, v46, vcc
    v_add_u32 v41, v41, v43
    v_mad_u32_u24 v154, v45, s39, v41
    v_mad_u32_u24 v155, v45, s45, v41
    v_add_u32 v40, s46, v19
    v_add_u32 v40, 4, v40
    v_mul_u32_u24 v41, 52429, v40
    v_lshrrev_b32 v41, 18, v41
    v_mul_u32_u24 v42, 5, v41
    v_sub_u32 v42, v40, v42
    v_mul_lo_u32 v41, v41, s41
    v_lshrrev_b32 v43, 1, v42
    v_lshl_add_u32 v43, v43, 8, v48
    v_and_b32 v44, 1, v42
    v_lshl_add_u32 v43, v44, 9, v43
    v_cmp_gt_u32 vcc, 4, v42
    v_mov_b32 v45, 256
    v_mov_b32 v46, s48
    v_cndmask_b32 v43, v49, v43, vcc
    v_cndmask_b32 v45, v45, v46, vcc
    v_add_u32 v41, v41, v43
    v_mad_u32_u24 v156, v45, s39, v41
    v_mad_u32_u24 v157, v45, s45, v41
    v_add_u32 v40, s46, v19
    v_add_u32 v40, 6, v40
    v_mul_u32_u24 v41, 52429, v40
    v_lshrrev_b32 v41, 18, v41
    v_mul_u32_u24 v42, 5, v41
    v_sub_u32 v42, v40, v42
    v_mul_lo_u32 v41, v41, s41
    v_lshrrev_b32 v43, 1, v42
    v_lshl_add_u32 v43, v43, 8, v48
    v_and_b32 v44, 1, v42
    v_lshl_add_u32 v43, v44, 9, v43
    v_cmp_gt_u32 vcc, 4, v42
    v_mov_b32 v45, 256
    v_mov_b32 v46, s48
    v_cndmask_b32 v43, v49, v43, vcc
    v_cndmask_b32 v45, v45, v46, vcc
    v_add_u32 v41, v41, v43
    v_mad_u32_u24 v158, v45, s39, v41
    v_mad_u32_u24 v159, v45, s45, v41
    v_add_u32 v40, s47, v19
    v_add_u32 v40, 0, v40
    v_mul_u32_u24 v41, 52429, v40
    v_lshrrev_b32 v41, 18, v41
    v_mul_u32_u24 v42, 5, v41
    v_sub_u32 v42, v40, v42
    v_mul_lo_u32 v41, v41, s41
    v_lshrrev_b32 v43, 1, v42
    v_lshl_add_u32 v43, v43, 8, v48
    v_and_b32 v44, 1, v42
    v_lshl_add_u32 v43, v44, 9, v43
    v_cmp_gt_u32 vcc, 4, v42
    v_mov_b32 v45, 256
    v_mov_b32 v46, s48
    v_cndmask_b32 v43, v49, v43, vcc
    v_cndmask_b32 v45, v45, v46, vcc
    v_add_u32 v41, v41, v43
    v_mad_u32_u24 v160, v45, s39, v41
    v_mad_u32_u24 v161, v45, s45, v41
    v_add_u32 v40, s47, v19
    v_add_u32 v40, 2, v40
    v_mul_u32_u24 v41, 52429, v40
    v_lshrrev_b32 v41, 18, v41
    v_mul_u32_u24 v42, 5, v41
    v_sub_u32 v42, v40, v42
    v_mul_lo_u32 v41, v41, s41
    v_lshrrev_b32 v43, 1, v42
    v_lshl_add_u32 v43, v43, 8, v48
    v_and_b32 v44, 1, v42
    v_lshl_add_u32 v43, v44, 9, v43
    v_cmp_gt_u32 vcc, 4, v42
    v_mov_b32 v45, 256
    v_mov_b32 v46, s48
    v_cndmask_b32 v43, v49, v43, vcc
    v_cndmask_b32 v45, v45, v46, vcc
    v_add_u32 v41, v41, v43
    v_mad_u32_u24 v162, v45, s39, v41
    v_mad_u32_u24 v163, v45, s45, v41
    v_add_u32 v40, s47, v19
    v_add_u32 v40, 4, v40
    v_mul_u32_u24 v41, 52429, v40
    v_lshrrev_b32 v41, 18, v41
    v_mul_u32_u24 v42, 5, v41
    v_sub_u32 v42, v40, v42
    v_mul_lo_u32 v41, v41, s41
    v_lshrrev_b32 v43, 1, v42
    v_lshl_add_u32 v43, v43, 8, v48
    v_and_b32 v44, 1, v42
    v_lshl_add_u32 v43, v44, 9, v43
    v_cmp_gt_u32 vcc, 4, v42
    v_mov_b32 v45, 256
    v_mov_b32 v46, s48
    v_cndmask_b32 v43, v49, v43, vcc
    v_cndmask_b32 v45, v45, v46, vcc
    v_add_u32 v41, v41, v43
    v_mad_u32_u24 v164, v45, s39, v41
    v_mad_u32_u24 v165, v45, s45, v41
    v_add_u32 v40, s47, v19
    v_add_u32 v40, 6, v40
    v_mul_u32_u24 v41, 52429, v40
    v_lshrrev_b32 v41, 18, v41
    v_mul_u32_u24 v42, 5, v41
    v_sub_u32 v42, v40, v42
    v_mul_lo_u32 v41, v41, s41
    v_lshrrev_b32 v43, 1, v42
    v_lshl_add_u32 v43, v43, 8, v48
    v_and_b32 v44, 1, v42
    v_lshl_add_u32 v43, v44, 9, v43
    v_cmp_gt_u32 vcc, 4, v42
    v_mov_b32 v45, 256
    v_mov_b32 v46, s48
    v_cndmask_b32 v43, v49, v43, vcc
    v_cndmask_b32 v45, v45, v46, vcc
    v_add_u32 v41, v41, v43
    v_mad_u32_u24 v166, v45, s39, v41
    v_mad_u32_u24 v167, v45, s45, v41
    s_mov_b32 s50, 0
    s_mov_b32 s53, 10
    s_barrier
    ds_read_b128 v[32:35], v8
    ds_read_b128 v[36:39], v12
    ds_read_b64_tr_b16 v[40:41], v16 offset:0
    ds_read_b64_tr_b16 v[42:43], v16 offset:1024
    ds_read_b64_tr_b16 v[44:45], v17 offset:0
    ds_read_b64_tr_b16 v[46:47], v17 offset:1024
    s_cmp_ge_u32 s25, 10
    s_cbranch_scc1 qkv_vloop
qkv_qkloop:
    s_add_u32 s50, s50, 0x8000
    s_and_b32 s50, s50, 0x1ffff
    s_waitcnt lgkmcnt(0)
    v_mfma_f32_32x32x16_bf16 v[64:79], v[40:43], v[32:35], v[64:79]
    ds_read_b128 v[48:51], v9
    ds_read_b128 v[52:55], v13
    ds_read_b64_tr_b16 v[56:57], v16 offset:4096
    v_mfma_f32_32x32x16_bf16 v[80:95], v[44:47], v[32:35], v[80:95]
    ds_read_b64_tr_b16 v[58:59], v16 offset:5120
    ds_read_b64_tr_b16 v[60:61], v17 offset:4096
    ds_read_b64_tr_b16 v[62:63], v17 offset:5120
    v_mfma_f32_16x16x32_bf16 v[144:147], v[140:143], v[32:35], v[144:147]
    v_mfma_f32_32x32x16_bf16 v[96:111], v[40:43], v[36:39], v[96:111]
    v_mfma_f32_16x16x32_bf16 v[148:151], v[140:143], v[40:43], v[148:151]
    v_mfma_f32_32x32x16_bf16 v[112:127], v[44:47], v[36:39], v[112:127]
    s_waitcnt lgkmcnt(0)
    v_mfma_f32_32x32x16_bf16 v[64:79], v[56:59], v[48:51], v[64:79]
    ds_read_b128 v[32:35], v10
    ds_read_b128 v[36:39], v14
    ds_read_b64_tr_b16 v[40:41], v16 offset:8192
    v_mfma_f32_32x32x16_bf16 v[80:95], v[60:63], v[48:51], v[80:95]
    ds_read_b64_tr_b16 v[42:43], v16 offset:9216
    ds_read_b64_tr_b16 v[44:45], v17 offset:8192
    ds_read_b64_tr_b16 v[46:47], v17 offset:9216
    v_mfma_f32_16x16x32_bf16 v[144:147], v[140:143], v[48:51], v[144:147]
    v_mfma_f32_32x32x16_bf16 v[96:111], v[56:59], v[52:55], v[96:111]
    v_mfma_f32_16x16x32_bf16 v[148:151], v[140:143], v[56:59], v[148:151]
    v_mfma_f32_32x32x16_bf16 v[112:127], v[60:63], v[52:55], v[112:127]
    s_waitcnt lgkmcnt(0)
    v_mfma_f32_32x32x16_bf16 v[64:79], v[40:43], v[32:35], v[64:79]
    ds_read_b128 v[48:51], v11
    ds_read_b128 v[52:55], v15
    ds_read_b64_tr_b16 v[56:57], v16 offset:12288
    v_mfma_f32_32x32x16_bf16 v[80:95], v[44:47], v[32:35], v[80:95]
    ds_read_b64_tr_b16 v[58:59], v16 offset:13312
    ds_read_b64_tr_b16 v[60:61], v17 offset:12288
    ds_read_b64_tr_b16 v[62:63], v17 offset:13312
    v_mfma_f32_16x16x32_bf16 v[144:147], v[140:143], v[32:35], v[144:147]
    v_mfma_f32_32x32x16_bf16 v[96:111], v[40:43], v[36:39], v[96:111]
    v_mfma_f32_16x16x32_bf16 v[148:151], v[140:143], v[40:43], v[148:151]
    v_mfma_f32_32x32x16_bf16 v[112:127], v[44:47], v[36:39], v[112:127]
    s_waitcnt lgkmcnt(0)
    v_mfma_f32_32x32x16_bf16 v[64:79], v[56:59], v[48:51], v[64:79]
    v_add_u32 v8, s50, v128
    v_add_u32 v9, s50, v129
    v_add_u32 v10, s50, v130
    v_add_u32 v11, s50, v131
    v_add_u32 v12, s50, v132
    v_mfma_f32_32x32x16_bf16 v[80:95], v[60:63], v[48:51], v[80:95]
    v_add_u32 v13, s50, v133
    v_add_u32 v14, s50, v134
    v_add_u32 v15, s50, v135
    v_add_u32 v16, s50, v136
    v_add_u32 v17, s50, v137
    s_barrier
    v_mfma_f32_16x16x32_bf16 v[144:147], v[140:143], v[48:51], v[144:147]
    ds_read_b128 v[32:35], v8
    ds_read_b128 v[36:39], v12
    ds_read_b64_tr_b16 v[40:41], v16 offset:0
    v_mfma_f32_32x32x16_bf16 v[96:111], v[56:59], v[52:55], v[96:111]
    ds_read_b64_tr_b16 v[42:43], v16 offset:1024
    ds_read_b64_tr_b16 v[44:45], v17 offset:0
    ds_read_b64_tr_b16 v[46:47], v17 offset:1024
    v_mfma_f32_16x16x32_bf16 v[148:151], v[140:143], v[56:59], v[148:151]
    v_mfma_f32_32x32x16_bf16 v[112:127], v[60:63], v[52:55], v[112:127]
    s_sub_u32 s53, s53, 1
    s_cmp_lg_u32 s53, 0
    s_cbranch_scc1 qkv_qkloop
    s_waitcnt lgkmcnt(0)
    s_lshl_b32 s31, s26, 7
    s_add_u32 s31, s31, 0x20600
    v_lshl_add_u32 v28, v18, 2, s31
    ds_read_b32 v25, v28
    s_lshl_b32 s32, s25, 7
    s_lshl_b32 s33, s28, 6
    s_add_u32 s32, s32, s33
    s_lshl_b32 s33, s27, 5
    s_add_u32 s32, s32, s33
    s_lshl_b32 s32, s32, 2
    s_add_u32 s32, s32, 18825216
    v_lshlrev_b32 v21, 2, v18
    s_cmp_lg_u32 s24, 0
    s_cbranch_scc1 qkv_nocsqk
    buffer_store_dword v148, v21, s[20:23], s32 offen
qkv_nocsqk:
    v_mov_b32 v26, v148
    v_mul_f32 v24, 0x3acccccd, v144
    s_waitcnt lgkmcnt(0)
    v_mul_f32 v25, 0x3acccccd, v25
    v_fma_f32 v25, -v24, v24, v25
    v_max_f32 v25, 0, v25
    v_add_f32 v25, 0x3727c5ac, v25
    v_rsq_f32 v25, v25
    s_cmp_lt_u32 s25, 5
    s_cselect_b32 s31, 0x3ea52b5c, 1.0
    v_mul_f32 v25, s31, v25
    v_mul_f32 v27, -v24, v25
    s_lshl_b32 s31, s27, 8
    s_lshl_b32 s32, s28, 7
    s_add_u32 s33, s31, s32
    s_add_u32 s33, s33, 0x20000
    v_lshl_add_u32 v28, v18, 2, s33
    ds_write_b32 v28, v25
    ds_write_b32 v28, v27 offset:512
    s_lshl_b32 s31, s28, 8
    s_lshl_b32 s32, s27, 7
    s_add_u32 s37, s31, s32
    s_add_u32 s37, s37, 0x20400
    v_lshl_add_u32 v29, v18, 2, s37
    ds_write_b32 v29, v26
    s_waitcnt lgkmcnt(0)
    s_barrier
    s_lshr_b32 s38, s24, 1
    s_and_b32 s39, s24, 1
    s_lshl_b32 s39, s39, 2
    s_lshl_b32 s31, s27, 1
    s_add_u32 s39, s39, s31
    v_xor_b32 v30, 128, v28
    ds_read_b32 v32, v28
    ds_read_b32 v33, v28 offset:512
    ds_read_b32 v34, v30
    ds_read_b32 v35, v30 offset:512
    v_lshl_add_u32 v31, v19, 4, s37
    v_xor_b32 v30, 128, v31
    ds_read_b128 v[36:39], v31 offset:0
    ds_read_b128 v[40:43], v31 offset:32
    ds_read_b128 v[44:47], v31 offset:64
    ds_read_b128 v[48:51], v31 offset:96
    ds_read_b128 v[128:131], v30 offset:0
    ds_read_b128 v[132:135], v30 offset:32
    ds_read_b128 v[136:139], v30 offset:64
    ds_read_b128 v[140:143], v30 offset:96
    s_waitcnt lgkmcnt(0)
    v_pk_mul_f32 v[64:65], v[32:33], v[64:65] op_sel_hi:[0,1]
    v_pk_mul_f32 v[66:67], v[32:33], v[66:67] op_sel_hi:[0,1]
    v_pk_fma_f32 v[64:65], v[32:33], v[36:37], v[64:65] op_sel:[1,0,0] op_sel_hi:[1,1,1]
    v_pk_fma_f32 v[66:67], v[32:33], v[38:39], v[66:67] op_sel:[1,0,0] op_sel_hi:[1,1,1]
    v_cvt_pk_bf16_f32 v64, v64, v65
    v_cvt_pk_bf16_f32 v65, v66, v67
    buffer_store_dwordx2 v[64:65], v152, s[20:23], s43 offen
    v_pk_mul_f32 v[96:97], v[34:35], v[96:97] op_sel_hi:[0,1]
    v_pk_mul_f32 v[98:99], v[34:35], v[98:99] op_sel_hi:[0,1]
    v_pk_fma_f32 v[96:97], v[34:35], v[36:37], v[96:97] op_sel:[1,0,0] op_sel_hi:[1,1,1]
    v_pk_fma_f32 v[98:99], v[34:35], v[38:39], v[98:99] op_sel:[1,0,0] op_sel_hi:[1,1,1]
    v_cvt_pk_bf16_f32 v96, v96, v97
    v_cvt_pk_bf16_f32 v97, v98, v99
    buffer_store_dwordx2 v[96:97], v153, s[20:23], s43 offen
    v_pk_mul_f32 v[68:69], v[32:33], v[68:69] op_sel_hi:[0,1]
    v_pk_mul_f32 v[70:71], v[32:33], v[70:71] op_sel_hi:[0,1]
    v_pk_fma_f32 v[68:69], v[32:33], v[40:41], v[68:69] op_sel:[1,0,0] op_sel_hi:[1,1,1]
    v_pk_fma_f32 v[70:71], v[32:33], v[42:43], v[70:71] op_sel:[1,0,0] op_sel_hi:[1,1,1]
    v_cvt_pk_bf16_f32 v68, v68, v69
    v_cvt_pk_bf16_f32 v69, v70, v71
    buffer_store_dwordx2 v[68:69], v154, s[20:23], s43 offen
    v_pk_mul_f32 v[100:101], v[34:35], v[100:101] op_sel_hi:[0,1]
    v_pk_mul_f32 v[102:103], v[34:35], v[102:103] op_sel_hi:[0,1]
    v_pk_fma_f32 v[100:101], v[34:35], v[40:41], v[100:101] op_sel:[1,0,0] op_sel_hi:[1,1,1]
    v_pk_fma_f32 v[102:103], v[34:35], v[42:43], v[102:103] op_sel:[1,0,0] op_sel_hi:[1,1,1]
    v_cvt_pk_bf16_f32 v100, v100, v101
    v_cvt_pk_bf16_f32 v101, v102, v103
    buffer_store_dwordx2 v[100:101], v155, s[20:23], s43 offen
    v_pk_mul_f32 v[72:73], v[32:33], v[72:73] op_sel_hi:[0,1]
    v_pk_mul_f32 v[74:75], v[32:33], v[74:75] op_sel_hi:[0,1]
    v_pk_fma_f32 v[72:73], v[32:33], v[44:45], v[72:73] op_sel:[1,0,0] op_sel_hi:[1,1,1]
    v_pk_fma_f32 v[74:75], v[32:33], v[46:47], v[74:75] op_sel:[1,0,0] op_sel_hi:[1,1,1]
    v_cvt_pk_bf16_f32 v72, v72, v73
    v_cvt_pk_bf16_f32 v73, v74, v75
    buffer_store_dwordx2 v[72:73], v156, s[20:23], s43 offen
    v_pk_mul_f32 v[104:105], v[34:35], v[104:105] op_sel_hi:[0,1]
    v_pk_mul_f32 v[106:107], v[34:35], v[106:107] op_sel_hi:[0,1]
    v_pk_fma_f32 v[104:105], v[34:35], v[44:45], v[104:105] op_sel:[1,0,0] op_sel_hi:[1,1,1]
    v_pk_fma_f32 v[106:107], v[34:35], v[46:47], v[106:107] op_sel:[1,0,0] op_sel_hi:[1,1,1]
    v_cvt_pk_bf16_f32 v104, v104, v105
    v_cvt_pk_bf16_f32 v105, v106, v107
    buffer_store_dwordx2 v[104:105], v157, s[20:23], s43 offen
    v_pk_mul_f32 v[76:77], v[32:33], v[76:77] op_sel_hi:[0,1]
    v_pk_mul_f32 v[78:79], v[32:33], v[78:79] op_sel_hi:[0,1]
    v_pk_fma_f32 v[76:77], v[32:33], v[48:49], v[76:77] op_sel:[1,0,0] op_sel_hi:[1,1,1]
    v_pk_fma_f32 v[78:79], v[32:33], v[50:51], v[78:79] op_sel:[1,0,0] op_sel_hi:[1,1,1]
    v_cvt_pk_bf16_f32 v76, v76, v77
    v_cvt_pk_bf16_f32 v77, v78, v79
    buffer_store_dwordx2 v[76:77], v158, s[20:23], s43 offen
    v_pk_mul_f32 v[108:109], v[34:35], v[108:109] op_sel_hi:[0,1]
    v_pk_mul_f32 v[110:111], v[34:35], v[110:111] op_sel_hi:[0,1]
    v_pk_fma_f32 v[108:109], v[34:35], v[48:49], v[108:109] op_sel:[1,0,0] op_sel_hi:[1,1,1]
    v_pk_fma_f32 v[110:111], v[34:35], v[50:51], v[110:111] op_sel:[1,0,0] op_sel_hi:[1,1,1]
    v_cvt_pk_bf16_f32 v108, v108, v109
    v_cvt_pk_bf16_f32 v109, v110, v111
    buffer_store_dwordx2 v[108:109], v159, s[20:23], s43 offen
    v_pk_mul_f32 v[80:81], v[32:33], v[80:81] op_sel_hi:[0,1]
    v_pk_mul_f32 v[82:83], v[32:33], v[82:83] op_sel_hi:[0,1]
    v_pk_fma_f32 v[80:81], v[32:33], v[128:129], v[80:81] op_sel:[1,0,0] op_sel_hi:[1,1,1]
    v_pk_fma_f32 v[82:83], v[32:33], v[130:131], v[82:83] op_sel:[1,0,0] op_sel_hi:[1,1,1]
    v_cvt_pk_bf16_f32 v80, v80, v81
    v_cvt_pk_bf16_f32 v81, v82, v83
    buffer_store_dwordx2 v[80:81], v160, s[20:23], s43 offen
    v_pk_mul_f32 v[112:113], v[34:35], v[112:113] op_sel_hi:[0,1]
    v_pk_mul_f32 v[114:115], v[34:35], v[114:115] op_sel_hi:[0,1]
    v_pk_fma_f32 v[112:113], v[34:35], v[128:129], v[112:113] op_sel:[1,0,0] op_sel_hi:[1,1,1]
    v_pk_fma_f32 v[114:115], v[34:35], v[130:131], v[114:115] op_sel:[1,0,0] op_sel_hi:[1,1,1]
    v_cvt_pk_bf16_f32 v112, v112, v113
    v_cvt_pk_bf16_f32 v113, v114, v115
    buffer_store_dwordx2 v[112:113], v161, s[20:23], s43 offen
    v_pk_mul_f32 v[84:85], v[32:33], v[84:85] op_sel_hi:[0,1]
    v_pk_mul_f32 v[86:87], v[32:33], v[86:87] op_sel_hi:[0,1]
    v_pk_fma_f32 v[84:85], v[32:33], v[132:133], v[84:85] op_sel:[1,0,0] op_sel_hi:[1,1,1]
    v_pk_fma_f32 v[86:87], v[32:33], v[134:135], v[86:87] op_sel:[1,0,0] op_sel_hi:[1,1,1]
    v_cvt_pk_bf16_f32 v84, v84, v85
    v_cvt_pk_bf16_f32 v85, v86, v87
    buffer_store_dwordx2 v[84:85], v162, s[20:23], s43 offen
    v_pk_mul_f32 v[116:117], v[34:35], v[116:117] op_sel_hi:[0,1]
    v_pk_mul_f32 v[118:119], v[34:35], v[118:119] op_sel_hi:[0,1]
    v_pk_fma_f32 v[116:117], v[34:35], v[132:133], v[116:117] op_sel:[1,0,0] op_sel_hi:[1,1,1]
    v_pk_fma_f32 v[118:119], v[34:35], v[134:135], v[118:119] op_sel:[1,0,0] op_sel_hi:[1,1,1]
    v_cvt_pk_bf16_f32 v116, v116, v117
    v_cvt_pk_bf16_f32 v117, v118, v119
    buffer_store_dwordx2 v[116:117], v163, s[20:23], s43 offen
    v_pk_mul_f32 v[88:89], v[32:33], v[88:89] op_sel_hi:[0,1]
    v_pk_mul_f32 v[90:91], v[32:33], v[90:91] op_sel_hi:[0,1]
    v_pk_fma_f32 v[88:89], v[32:33], v[136:137], v[88:89] op_sel:[1,0,0] op_sel_hi:[1,1,1]
    v_pk_fma_f32 v[90:91], v[32:33], v[138:139], v[90:91] op_sel:[1,0,0] op_sel_hi:[1,1,1]
    v_cvt_pk_bf16_f32 v88, v88, v89
    v_cvt_pk_bf16_f32 v89, v90, v91
    buffer_store_dwordx2 v[88:89], v164, s[20:23], s43 offen
    v_pk_mul_f32 v[120:121], v[34:35], v[120:121] op_sel_hi:[0,1]
    v_pk_mul_f32 v[122:123], v[34:35], v[122:123] op_sel_hi:[0,1]
    v_pk_fma_f32 v[120:121], v[34:35], v[136:137], v[120:121] op_sel:[1,0,0] op_sel_hi:[1,1,1]
    v_pk_fma_f32 v[122:123], v[34:35], v[138:139], v[122:123] op_sel:[1,0,0] op_sel_hi:[1,1,1]
    v_cvt_pk_bf16_f32 v120, v120, v121
    v_cvt_pk_bf16_f32 v121, v122, v123
    buffer_store_dwordx2 v[120:121], v165, s[20:23], s43 offen
    v_pk_mul_f32 v[92:93], v[32:33], v[92:93] op_sel_hi:[0,1]
    v_pk_mul_f32 v[94:95], v[32:33], v[94:95] op_sel_hi:[0,1]
    v_pk_fma_f32 v[92:93], v[32:33], v[140:141], v[92:93] op_sel:[1,0,0] op_sel_hi:[1,1,1]
    v_pk_fma_f32 v[94:95], v[32:33], v[142:143], v[94:95] op_sel:[1,0,0] op_sel_hi:[1,1,1]
    v_cvt_pk_bf16_f32 v92, v92, v93
    v_cvt_pk_bf16_f32 v93, v94, v95
    buffer_store_dwordx2 v[92:93], v166, s[20:23], s43 offen
    v_pk_mul_f32 v[124:125], v[34:35], v[124:125] op_sel_hi:[0,1]
    v_pk_mul_f32 v[126:127], v[34:35], v[126:127] op_sel_hi:[0,1]
    v_pk_fma_f32 v[124:125], v[34:35], v[140:141], v[124:125] op_sel:[1,0,0] op_sel_hi:[1,1,1]
    v_pk_fma_f32 v[126:127], v[34:35], v[142:143], v[126:127] op_sel:[1,0,0] op_sel_hi:[1,1,1]
    v_cvt_pk_bf16_f32 v124, v124, v125
    v_cvt_pk_bf16_f32 v125, v126, v127
    buffer_store_dwordx2 v[124:125], v167, s[20:23], s43 offen
    s_endpgm
qkv_vloop:
    s_add_u32 s50, s50, 0x8000
    s_and_b32 s50, s50, 0x1ffff
    s_waitcnt lgkmcnt(0)
    v_mfma_f32_32x32x16_bf16 v[64:79], v[32:35], v[40:43], v[64:79]
    ds_read_b128 v[48:51], v9
    ds_read_b128 v[52:55], v13
    ds_read_b64_tr_b16 v[56:57], v16 offset:4096
    v_mfma_f32_32x32x16_bf16 v[80:95], v[32:35], v[44:47], v[80:95]
    ds_read_b64_tr_b16 v[58:59], v16 offset:5120
    ds_read_b64_tr_b16 v[60:61], v17 offset:4096
    ds_read_b64_tr_b16 v[62:63], v17 offset:5120
    v_mfma_f32_16x16x32_bf16 v[144:147], v[140:143], v[32:35], v[144:147]
    v_mfma_f32_32x32x16_bf16 v[96:111], v[36:39], v[40:43], v[96:111]
    v_mfma_f32_16x16x32_bf16 v[148:151], v[140:143], v[40:43], v[148:151]
    v_mfma_f32_32x32x16_bf16 v[112:127], v[36:39], v[44:47], v[112:127]
    s_waitcnt lgkmcnt(0)
    v_mfma_f32_32x32x16_bf16 v[64:79], v[48:51], v[56:59], v[64:79]
    ds_read_b128 v[32:35], v10
    ds_read_b128 v[36:39], v14
    ds_read_b64_tr_b16 v[40:41], v16 offset:8192
    v_mfma_f32_32x32x16_bf16 v[80:95], v[48:51], v[60:63], v[80:95]
    ds_read_b64_tr_b16 v[42:43], v16 offset:9216
    ds_read_b64_tr_b16 v[44:45], v17 offset:8192
    ds_read_b64_tr_b16 v[46:47], v17 offset:9216
    v_mfma_f32_16x16x32_bf16 v[144:147], v[140:143], v[48:51], v[144:147]
    v_mfma_f32_32x32x16_bf16 v[96:111], v[52:55], v[56:59], v[96:111]
    v_mfma_f32_16x16x32_bf16 v[148:151], v[140:143], v[56:59], v[148:151]
    v_mfma_f32_32x32x16_bf16 v[112:127], v[52:55], v[60:63], v[112:127]
    s_waitcnt lgkmcnt(0)
    v_mfma_f32_32x32x16_bf16 v[64:79], v[32:35], v[40:43], v[64:79]
    ds_read_b128 v[48:51], v11
    ds_read_b128 v[52:55], v15
    ds_read_b64_tr_b16 v[56:57], v16 offset:12288
    v_mfma_f32_32x32x16_bf16 v[80:95], v[32:35], v[44:47], v[80:95]
    ds_read_b64_tr_b16 v[58:59], v16 offset:13312
    ds_read_b64_tr_b16 v[60:61], v17 offset:12288
    ds_read_b64_tr_b16 v[62:63], v17 offset:13312
    v_mfma_f32_16x16x32_bf16 v[144:147], v[140:143], v[32:35], v[144:147]
    v_mfma_f32_32x32x16_bf16 v[96:111], v[36:39], v[40:43], v[96:111]
    v_mfma_f32_16x16x32_bf16 v[148:151], v[140:143], v[40:43], v[148:151]
    v_mfma_f32_32x32x16_bf16 v[112:127], v[36:39], v[44:47], v[112:127]
    s_waitcnt lgkmcnt(0)
    v_mfma_f32_32x32x16_bf16 v[64:79], v[48:51], v[56:59], v[64:79]
    v_add_u32 v8, s50, v128
    v_add_u32 v9, s50, v129
    v_add_u32 v10, s50, v130
    v_add_u32 v11, s50, v131
    v_add_u32 v12, s50, v132
    v_mfma_f32_32x32x16_bf16 v[80:95], v[48:51], v[60:63], v[80:95]
    v_add_u32 v13, s50, v133
    v_add_u32 v14, s50, v134
    v_add_u32 v15, s50, v135
    v_add_u32 v16, s50, v136
    v_add_u32 v17, s50, v137
    s_barrier
    v_mfma_f32_16x16x32_bf16 v[144:147], v[140:143], v[48:51], v[144:147]
    ds_read_b128 v[32:35], v8
    ds_read_b128 v[36:39], v12
    ds_read_b64_tr_b16 v[40:41], v16 offset:0
    v_mfma_f32_32x32x16_bf16 v[96:111], v[52:55], v[56:59], v[96:111]
    ds_read_b64_tr_b16 v[42:43], v16 offset:1024
    ds_read_b64_tr_b16 v[44:45], v17 offset:0
    ds_read_b64_tr_b16 v[46:47], v17 offset:1024
    v_mfma_f32_16x16x32_bf16 v[148:151], v[140:143], v[56:59], v[148:151]
    v_mfma_f32_32x32x16_bf16 v[112:127], v[52:55], v[60:63], v[112:127]
    s_sub_u32 s53, s53, 1
    s_cmp_lg_u32 s53, 0
    s_cbranch_scc1 qkv_vloop
    s_waitcnt lgkmcnt(0)
    s_lshl_b32 s31, s26, 7
    s_add_u32 s31, s31, 0x20600
    v_lshl_add_u32 v28, v18, 2, s31
    ds_read_b32 v25, v28
    s_lshl_b32 s32, s25, 7
    s_lshl_b32 s33, s28, 6
    s_add_u32 s32, s32, s33
    s_lshl_b32 s33, s27, 5
    s_add_u32 s32, s32, s33
    s_lshl_b32 s32, s32, 2
    s_add_u32 s32, s32, 18825216
    v_lshlrev_b32 v21, 2, v18
    s_cmp_lg_u32 s24, 0
    s_cbranch_scc1 qkv_nocsv
    buffer_store_dword v148, v21, s[20:23], s32 offen
qkv_nocsv:
    v_mov_b32 v26, v148
    v_mul_f32 v24, 0x3acccccd, v144
    s_waitcnt lgkmcnt(0)
    v_mul_f32 v25, 0x3acccccd, v25
    v_fma_f32 v25, -v24, v24, v25
    v_max_f32 v25, 0, v25
    v_add_f32 v25, 0x3727c5ac, v25
    v_rsq_f32 v25, v25
    s_cmp_lt_u32 s25, 5
    s_cselect_b32 s31, 0x3ea52b5c, 1.0
    v_mul_f32 v25, s31, v25
    v_mul_f32 v27, -v24, v25
    s_lshl_b32 s31, s27, 8
    s_lshl_b32 s32, s28, 7
    s_add_u32 s33, s31, s32
    s_add_u32 s33, s33, 0x20000
    v_lshl_add_u32 v28, v18, 2, s33
    ds_write_b32 v28, v25
    ds_write_b32 v28, v27 offset:512
    s_lshl_b32 s31, s28, 8
    s_lshl_b32 s32, s27, 7
    s_add_u32 s37, s31, s32
    s_add_u32 s37, s37, 0x20400
    v_lshl_add_u32 v29, v18, 2, s37
    ds_write_b32 v29, v26
    s_waitcnt lgkmcnt(0)
    s_barrier
    s_lshr_b32 s38, s24, 1
    s_and_b32 s39, s24, 1
    s_lshl_b32 s39, s39, 2
    s_lshl_b32 s31, s27, 1
    s_add_u32 s39, s39, s31
    s_mul_i32 s43, s38, 20480
    s_add_u32 s43, s43, 2631680
    s_add_u32 s39, s39, s28
    s_xor_b32 s45, s39, 1
    s_mul_i32 s39, s39, 1280
    s_mul_i32 s45, s45, 1280
    s_add_u32 s39, s39, s43
    s_add_u32 s45, s45, s43
    v_xor_b32 v30, 128, v29
    ds_read_b32 v32, v29
    ds_read_b32 v33, v30
    v_lshl_add_u32 v31, v19, 4, s33
    v_xor_b32 v30, 128, v31
    s_sub_u32 s31, s25, 10
    s_lshl_b32 s31, s31, 7
    s_lshl_b32 s32, s28, 6
    s_add_u32 s31, s31, s32
    s_lshl_b32 s32, s27, 5
    s_add_u32 s46, s31, s32
    s_xor_b32 s47, s46, 32
    s_mov_b32 s41, 163840
    v_add_u32 v8, s46, v18
    v_mul_u32_u24 v9, 52429, v8
    v_lshrrev_b32 v9, 20, v9
    v_mul_u32_u24 v10, 20, v9
    v_sub_u32 v10, v8, v10
    v_mul_lo_u32 v9, v9, s41
    v_lshl_add_u32 v9, v10, 4, v9
    v_mul_u32_u24 v10, 320, v19
    v_add_u32 v14, v9, v10
    v_add_u32 v8, s47, v18
    v_mul_u32_u24 v9, 52429, v8
    v_lshrrev_b32 v9, 20, v9
    v_mul_u32_u24 v10, 20, v9
    v_sub_u32 v10, v8, v10
    v_mul_lo_u32 v9, v9, s41
    v_lshl_add_u32 v9, v10, 4, v9
    v_mul_u32_u24 v10, 320, v19
    v_add_u32 v15, v9, v10
    ds_read_b128 v[36:39], v31 offset:0
    ds_read_b128 v[128:131], v31 offset:512
    ds_read_b128 v[40:43], v31 offset:32
    ds_read_b128 v[132:135], v31 offset:544
    ds_read_b128 v[44:47], v31 offset:64
    ds_read_b128 v[136:139], v31 offset:576
    ds_read_b128 v[48:51], v31 offset:96
    ds_read_b128 v[140:143], v31 offset:608
    s_waitcnt lgkmcnt(0)
    v_pk_mul_f32 v[64:65], v[36:37], v[64:65]
    v_pk_mul_f32 v[66:67], v[38:39], v[66:67]
    v_pk_mul_f32 v[68:69], v[40:41], v[68:69]
    v_pk_mul_f32 v[70:71], v[42:43], v[70:71]
    v_pk_mul_f32 v[72:73], v[44:45], v[72:73]
    v_pk_mul_f32 v[74:75], v[46:47], v[74:75]
    v_pk_mul_f32 v[76:77], v[48:49], v[76:77]
    v_pk_mul_f32 v[78:79], v[50:51], v[78:79]
    v_pk_fma_f32 v[64:65], v[128:129], v[32:33], v[64:65] op_sel:[0,0,0] op_sel_hi:[1,0,1]
    v_pk_fma_f32 v[66:67], v[130:131], v[32:33], v[66:67] op_sel:[0,0,0] op_sel_hi:[1,0,1]
    v_pk_fma_f32 v[68:69], v[132:133], v[32:33], v[68:69] op_sel:[0,0,0] op_sel_hi:[1,0,1]
    v_pk_fma_f32 v[70:71], v[134:135], v[32:33], v[70:71] op_sel:[0,0,0] op_sel_hi:[1,0,1]
    v_pk_fma_f32 v[72:73], v[136:137], v[32:33], v[72:73] op_sel:[0,0,0] op_sel_hi:[1,0,1]
    v_pk_fma_f32 v[74:75], v[138:139], v[32:33], v[74:75] op_sel:[0,0,0] op_sel_hi:[1,0,1]
    v_pk_fma_f32 v[76:77], v[140:141], v[32:33], v[76:77] op_sel:[0,0,0] op_sel_hi:[1,0,1]
    v_pk_fma_f32 v[78:79], v[142:143], v[32:33], v[78:79] op_sel:[0,0,0] op_sel_hi:[1,0,1]
    v_cvt_pk_bf16_f32 v64, v64, v65
    v_cvt_pk_bf16_f32 v65, v66, v67
    v_cvt_pk_bf16_f32 v66, v68, v69
    v_cvt_pk_bf16_f32 v67, v70, v71
    v_cvt_pk_bf16_f32 v68, v72, v73
    v_cvt_pk_bf16_f32 v69, v74, v75
    v_cvt_pk_bf16_f32 v70, v76, v77
    v_cvt_pk_bf16_f32 v71, v78, v79
    buffer_store_dwordx4 v[64:67], v14, s[20:23], s39 offen
    buffer_store_dwordx4 v[68:71], v14, s[20:23], s39 offen offset:640
    v_pk_mul_f32 v[80:81], v[36:37], v[80:81]
    v_pk_mul_f32 v[82:83], v[38:39], v[82:83]
    v_pk_mul_f32 v[84:85], v[40:41], v[84:85]
    v_pk_mul_f32 v[86:87], v[42:43], v[86:87]
    v_pk_mul_f32 v[88:89], v[44:45], v[88:89]
    v_pk_mul_f32 v[90:91], v[46:47], v[90:91]
    v_pk_mul_f32 v[92:93], v[48:49], v[92:93]
    v_pk_mul_f32 v[94:95], v[50:51], v[94:95]
    v_pk_fma_f32 v[80:81], v[128:129], v[32:33], v[80:81] op_sel:[0,1,0] op_sel_hi:[1,1,1]
    v_pk_fma_f32 v[82:83], v[130:131], v[32:33], v[82:83] op_sel:[0,1,0] op_sel_hi:[1,1,1]
    v_pk_fma_f32 v[84:85], v[132:133], v[32:33], v[84:85] op_sel:[0,1,0] op_sel_hi:[1,1,1]
    v_pk_fma_f32 v[86:87], v[134:135], v[32:33], v[86:87] op_sel:[0,1,0] op_sel_hi:[1,1,1]
    v_pk_fma_f32 v[88:89], v[136:137], v[32:33], v[88:89] op_sel:[0,1,0] op_sel_hi:[1,1,1]
    v_pk_fma_f32 v[90:91], v[138:139], v[32:33], v[90:91] op_sel:[0,1,0] op_sel_hi:[1,1,1]
    v_pk_fma_f32 v[92:93], v[140:141], v[32:33], v[92:93] op_sel:[0,1,0] op_sel_hi:[1,1,1]
    v_pk_fma_f32 v[94:95], v[142:143], v[32:33], v[94:95] op_sel:[0,1,0] op_sel_hi:[1,1,1]
    v_cvt_pk_bf16_f32 v80, v80, v81
    v_cvt_pk_bf16_f32 v81, v82, v83
    v_cvt_pk_bf16_f32 v82, v84, v85
    v_cvt_pk_bf16_f32 v83, v86, v87
    v_cvt_pk_bf16_f32 v84, v88, v89
    v_cvt_pk_bf16_f32 v85, v90, v91
    v_cvt_pk_bf16_f32 v86, v92, v93
    v_cvt_pk_bf16_f32 v87, v94, v95
    buffer_store_dwordx4 v[80:83], v15, s[20:23], s39 offen
    buffer_store_dwordx4 v[84:87], v15, s[20:23], s39 offen offset:640
    ds_read_b128 v[36:39], v30 offset:0
    ds_read_b128 v[128:131], v30 offset:512
    ds_read_b128 v[40:43], v30 offset:32
    ds_read_b128 v[132:135], v30 offset:544
    ds_read_b128 v[44:47], v30 offset:64
    ds_read_b128 v[136:139], v30 offset:576
    ds_read_b128 v[48:51], v30 offset:96
    ds_read_b128 v[140:143], v30 offset:608
    s_waitcnt lgkmcnt(0)
    v_pk_mul_f32 v[96:97], v[36:37], v[96:97]
    v_pk_mul_f32 v[98:99], v[38:39], v[98:99]
    v_pk_mul_f32 v[100:101], v[40:41], v[100:101]
    v_pk_mul_f32 v[102:103], v[42:43], v[102:103]
    v_pk_mul_f32 v[104:105], v[44:45], v[104:105]
    v_pk_mul_f32 v[106:107], v[46:47], v[106:107]
    v_pk_mul_f32 v[108:109], v[48:49], v[108:109]
    v_pk_mul_f32 v[110:111], v[50:51], v[110:111]
    v_pk_fma_f32 v[96:97], v[128:129], v[32:33], v[96:97] op_sel:[0,0,0] op_sel_hi:[1,0,1]
    v_pk_fma_f32 v[98:99], v[130:131], v[32:33], v[98:99] op_sel:[0,0,0] op_sel_hi:[1,0,1]
    v_pk_fma_f32 v[100:101], v[132:133], v[32:33], v[100:101] op_sel:[0,0,0] op_sel_hi:[1,0,1]
    v_pk_fma_f32 v[102:103], v[134:135], v[32:33], v[102:103] op_sel:[0,0,0] op_sel_hi:[1,0,1]
    v_pk_fma_f32 v[104:105], v[136:137], v[32:33], v[104:105] op_sel:[0,0,0] op_sel_hi:[1,0,1]
    v_pk_fma_f32 v[106:107], v[138:139], v[32:33], v[106:107] op_sel:[0,0,0] op_sel_hi:[1,0,1]
    v_pk_fma_f32 v[108:109], v[140:141], v[32:33], v[108:109] op_sel:[0,0,0] op_sel_hi:[1,0,1]
    v_pk_fma_f32 v[110:111], v[142:143], v[32:33], v[110:111] op_sel:[0,0,0] op_sel_hi:[1,0,1]
    v_cvt_pk_bf16_f32 v96, v96, v97
    v_cvt_pk_bf16_f32 v97, v98, v99
    v_cvt_pk_bf16_f32 v98, v100, v101
    v_cvt_pk_bf16_f32 v99, v102, v103
    v_cvt_pk_bf16_f32 v100, v104, v105
    v_cvt_pk_bf16_f32 v101, v106, v107
    v_cvt_pk_bf16_f32 v102, v108, v109
    v_cvt_pk_bf16_f32 v103, v110, v111
    buffer_store_dwordx4 v[96:99], v14, s[20:23], s45 offen
    buffer_store_dwordx4 v[100:103], v14, s[20:23], s45 offen offset:640
    v_pk_mul_f32 v[112:113], v[36:37], v[112:113]
    v_pk_mul_f32 v[114:115], v[38:39], v[114:115]
    v_pk_mul_f32 v[116:117], v[40:41], v[116:117]
    v_pk_mul_f32 v[118:119], v[42:43], v[118:119]
    v_pk_mul_f32 v[120:121], v[44:45], v[120:121]
    v_pk_mul_f32 v[122:123], v[46:47], v[122:123]
    v_pk_mul_f32 v[124:125], v[48:49], v[124:125]
    v_pk_mul_f32 v[126:127], v[50:51], v[126:127]
    v_pk_fma_f32 v[112:113], v[128:129], v[32:33], v[112:113] op_sel:[0,1,0] op_sel_hi:[1,1,1]
    v_pk_fma_f32 v[114:115], v[130:131], v[32:33], v[114:115] op_sel:[0,1,0] op_sel_hi:[1,1,1]
    v_pk_fma_f32 v[116:117], v[132:133], v[32:33], v[116:117] op_sel:[0,1,0] op_sel_hi:[1,1,1]
    v_pk_fma_f32 v[118:119], v[134:135], v[32:33], v[118:119] op_sel:[0,1,0] op_sel_hi:[1,1,1]
    v_pk_fma_f32 v[120:121], v[136:137], v[32:33], v[120:121] op_sel:[0,1,0] op_sel_hi:[1,1,1]
    v_pk_fma_f32 v[122:123], v[138:139], v[32:33], v[122:123] op_sel:[0,1,0] op_sel_hi:[1,1,1]
    v_pk_fma_f32 v[124:125], v[140:141], v[32:33], v[124:125] op_sel:[0,1,0] op_sel_hi:[1,1,1]
    v_pk_fma_f32 v[126:127], v[142:143], v[32:33], v[126:127] op_sel:[0,1,0] op_sel_hi:[1,1,1]
    v_cvt_pk_bf16_f32 v112, v112, v113
    v_cvt_pk_bf16_f32 v113, v114, v115
    v_cvt_pk_bf16_f32 v114, v116, v117
    v_cvt_pk_bf16_f32 v115, v118, v119
    v_cvt_pk_bf16_f32 v116, v120, v121
    v_cvt_pk_bf16_f32 v117, v122, v123
    v_cvt_pk_bf16_f32 v118, v124, v125
    v_cvt_pk_bf16_f32 v119, v126, v127
    buffer_store_dwordx4 v[112:115], v15, s[20:23], s45 offen
    buffer_store_dwordx4 v[116:119], v15, s[20:23], s45 offen offset:640
qkv_end:
    s_endpgm
qkv_stat:
    s_sub_u32 s26, s26, 8
    s_lshl_b32 s50, s26, 12
    s_mov_b32 s53, 0
    s_mov_b32 s36, 0xffff0000
    v_lshl_add_u32 v12, v2, 4, s50
    v_mov_b32 v32, 0
    v_mov_b32 v33, 0
    v_mov_b32 v34, 0
    v_mov_b32 v35, 0
qkv_wk:
    s_barrier
    ds_read_b128 v[16:19], v12 offset:0
    ds_read_b128 v[20:23], v12 offset:1024
    ds_read_b128 v[24:27], v12 offset:2048
    ds_read_b128 v[28:31], v12 offset:3072
    v_add_u32 v12, 0x8000, v12
    v_and_b32 v12, 0x1ffff, v12
    s_waitcnt lgkmcnt(3)
    v_lshlrev_b32 v36, 16, v16
    v_and_b32 v37, s36, v16
    v_lshlrev_b32 v38, 16, v17
    v_and_b32 v39, s36, v17
    v_lshlrev_b32 v40, 16, v18
    v_and_b32 v41, s36, v18
    v_lshlrev_b32 v42, 16, v19
    v_and_b32 v43, s36, v19
    v_fmac_f32 v32, v36, v36
    v_fmac_f32 v32, v37, v37
    v_fmac_f32 v32, v38, v38
    v_fmac_f32 v32, v39, v39
    v_fmac_f32 v32, v40, v40
    v_fmac_f32 v32, v41, v41
    v_fmac_f32 v32, v42, v42
    v_fmac_f32 v32, v43, v43
    s_waitcnt lgkmcnt(2)
    v_lshlrev_b32 v36, 16, v20
    v_and_b32 v37, s36, v20
    v_lshlrev_b32 v38, 16, v21
    v_and_b32 v39, s36, v21
    v_lshlrev_b32 v40, 16, v22
    v_and_b32 v41, s36, v22
    v_lshlrev_b32 v42, 16, v23
    v_and_b32 v43, s36, v23
    v_fmac_f32 v33, v36, v36
    v_fmac_f32 v33, v37, v37
    v_fmac_f32 v33, v38, v38
    v_fmac_f32 v33, v39, v39
    v_fmac_f32 v33, v40, v40
    v_fmac_f32 v33, v41, v41
    v_fmac_f32 v33, v42, v42
    v_fmac_f32 v33, v43, v43
    s_waitcnt lgkmcnt(1)
    v_lshlrev_b32 v36, 16, v24
    v_and_b32 v37, s36, v24
    v_lshlrev_b32 v38, 16, v25
    v_and_b32 v39, s36, v25
    v_lshlrev_b32 v40, 16, v26
    v_and_b32 v41, s36, v26
    v_lshlrev_b32 v42, 16, v27
    v_and_b32 v43, s36, v27
    v_fmac_f32 v34, v36, v36
    v_fmac_f32 v34, v37, v37
    v_fmac_f32 v34, v38, v38
    v_fmac_f32 v34, v39, v39
    v_fmac_f32 v34, v40, v40
    v_fmac_f32 v34, v41, v41
    v_fmac_f32 v34, v42, v42
    v_fmac_f32 v34, v43, v43
    s_waitcnt lgkmcnt(0)
    v_lshlrev_b32 v36, 16, v28
    v_and_b32 v37, s36, v28
    v_lshlrev_b32 v38, 16, v29
    v_and_b32 v39, s36, v29
    v_lshlrev_b32 v40, 16, v30
    v_and_b32 v41, s36, v30
    v_lshlrev_b32 v42, 16, v31
    v_and_b32 v43, s36, v31
    v_fmac_f32 v35, v36, v36
    v_fmac_f32 v35, v37, v37
    v_fmac_f32 v35, v38, v38
    v_fmac_f32 v35, v39, v39
    v_fmac_f32 v35, v40, v40
    v_fmac_f32 v35, v41, v41
    v_fmac_f32 v35, v42, v42
    v_fmac_f32 v35, v43, v43
    s_add_u32 s53, s53, 1
    s_cmp_lt_u32 s53, 10
    s_cbranch_scc1 qkv_wk
    v_add_f32 v32, v32, v32 quad_perm:[1,0,3,2] row_mask:0xf bank_mask:0xf
    v_add_f32 v33, v33, v33 quad_perm:[1,0,3,2] row_mask:0xf bank_mask:0xf
    v_add_f32 v34, v34, v34 quad_perm:[1,0,3,2] row_mask:0xf bank_mask:0xf
    v_add_f32 v35, v35, v35 quad_perm:[1,0,3,2] row_mask:0xf bank_mask:0xf
    v_add_f32 v32, v32, v32 quad_perm:[2,3,0,1] row_mask:0xf bank_mask:0xf
    v_add_f32 v33, v33, v33 quad_perm:[2,3,0,1] row_mask:0xf bank_mask:0xf
    v_add_f32 v34, v34, v34 quad_perm:[2,3,0,1] row_mask:0xf bank_mask:0xf
    v_add_f32 v35, v35, v35 quad_perm:[2,3,0,1] row_mask:0xf bank_mask:0xf
    v_add_f32 v32, v32, v32 row_half_mirror row_mask:0xf bank_mask:0xf
    v_add_f32 v33, v33, v33 row_half_mirror row_mask:0xf bank_mask:0xf
    v_add_f32 v34, v34, v34 row_half_mirror row_mask:0xf bank_mask:0xf
    v_add_f32 v35, v35, v35 row_half_mirror row_mask:0xf bank_mask:0xf
    s_lshl_b32 s31, s26, 7
    s_add_u32 s31, s31, 0x20600
    v_lshrrev_b32 v13, 3, v2
    v_lshl_add_u32 v13, v13, 2, s31
    ds_write_b32 v13, v32 offset:0
    ds_write_b32 v13, v33 offset:32
    ds_write_b32 v13, v34 offset:64
    ds_write_b32 v13, v35 offset:96
    s_waitcnt lgkmcnt(0)
    s_barrier
    s_endpgm
qkv_repack:
    s_cmp_ge_u32 s26, 8
    s_cbranch_scc1 qkv_end
    s_load_dwordx2 s[4:5], s[0:1], 16
    v_lshlrev_b32 v3, 4, v2
    v_lshrrev_b32 v4, 4, v2
    v_bfe_u32 v5, v2, 2, 2
    v_lshl_add_u32 v4, v4, 3, v5
    v_mul_u32_u24 v4, 1280, v4
    s_mul_i32 s31, s26, 160
    v_add_u32 v4, s31, v4
    v_and_b32 v5, 3, v2
    v_lshl_add_u32 v6, v5, 3, v4
    v_lshl_add_u32 v5, v5, 4, v4
    s_mul_i32 s30, s26, 5120
    s_waitcnt lgkmcnt(0)
    s_mov_b32 s12, s4
    s_mov_b32 s13, s5
    s_mov_b32 s14, 819200
    s_mov_b32 s15, 0x20000
qkv_rp:
    s_mul_i32 s31, s24, 40960
    s_add_u32 s31, s31, s30
    s_add_u32 m0, s30, 0
    s_nop 0
    buffer_load_dwordx4 v3, s[12:15], s31 offen lds
    s_add_u32 s31, s31, 1024
    s_add_u32 m0, s30, 1024
    s_nop 0
    buffer_load_dwordx4 v3, s[12:15], s31 offen lds
    s_add_u32 s31, s31, 1024
    s_add_u32 m0, s30, 2048
    s_nop 0
    buffer_load_dwordx4 v3, s[12:15], s31 offen lds
    s_add_u32 s31, s31, 1024
    s_add_u32 m0, s30, 3072
    s_nop 0
    buffer_load_dwordx4 v3, s[12:15], s31 offen lds
    s_add_u32 s31, s31, 1024
    s_add_u32 m0, s30, 4096
    s_nop 0
    buffer_load_dwordx4 v3, s[12:15], s31 offen lds
    s_add_u32 s31, s31, 1024
    s_waitcnt vmcnt(0)
    s_barrier
    ds_read_b64_tr_b16 v[16:17], v5 offset:0
    ds_read_b64_tr_b16 v[18:19], v5 offset:5120
    ds_read_b64_tr_b16 v[20:21], v5 offset:8
    ds_read_b64_tr_b16 v[22:23], v5 offset:5128
    ds_read_b64_tr_b16 v[24:25], v5 offset:64
    ds_read_b64_tr_b16 v[26:27], v5 offset:5184
    ds_read_b64_tr_b16 v[28:29], v5 offset:72
    ds_read_b64_tr_b16 v[30:31], v5 offset:5192
    ds_read_b64_tr_b16 v[32:33], v6 offset:128
    ds_read_b64_tr_b16 v[34:35], v6 offset:5248
    s_mul_i32 s31, s26, 20
    s_add_u32 s31, s31, s24
    s_mul_i32 s31, s31, 5120
    s_add_u32 s31, s31, 17727488
    s_waitcnt lgkmcnt(0)
    s_barrier
    buffer_store_dwordx4 v[16:19], v3, s[20:23], s31 offen offset:0
    buffer_store_dwordx4 v[20:23], v3, s[20:23], s31 offen offset:1024
    buffer_store_dwordx4 v[24:27], v3, s[20:23], s31 offen offset:2048
    buffer_store_dwordx4 v[28:31], v3, s[20:23], s31 offen offset:3072
    s_add_u32 s31, s31, 4096
    buffer_store_dwordx4 v[32:35], v3, s[20:23], s31 offen
    s_add_u32 s24, s24, 16
    s_cmp_lt_u32 s24, 20
    s_cbranch_scc1 qkv_rp
    s_endpgm
.globl mega_kernel
.p2align 8
.type mega_kernel,@function
mega_kernel:
    s_load_dwordx2 s[8:9], s[0:1], 80
    s_mov_b32 s60, 0
    s_cmp_ge_u32 s2, 256
    s_cbranch_scc1 att_end
    v_lshrrev_b32 v1, 6, v0
    v_and_b32 v2, 63, v0
    v_mov_b32 v240, 0
    s_mov_b32 s90, 0
    v_readfirstlane_b32 s26, v1
att_l1:
    s_and_b32 s24, s2, 7
    s_lshl_b32 s24, s24, 2
    s_lshr_b32 s25, s2, 3
    s_and_b32 s27, s25, 3
    s_add_u32 s24, s24, s27
    s_lshr_b32 s25, s2, 5
    v_lshlrev_b32 v5, 4, v0
    s_mul_i32 s30, s24, 163840
    s_add_u32 s30, s30, 2621440
    s_lshl_b32 s31, s26, 10
    s_cmp_eq_u32 s60, 0
    s_cbranch_scc1 att_nox2
    s_barrier
att_nox2:
    s_cmp_lt_u32 s26, 4
    s_waitcnt lgkmcnt(0)
    s_mov_b32 s12, s8
    s_mov_b32 s13, s9
    s_mov_b32 s14, 17694720
    s_mov_b32 s15, 0x20000
    s_cbranch_scc1 att_cmp
    s_setprio 3
    v_subrev_u32 v5, 4096, v5
    s_sub_u32 s31, s31, 4096
    s_add_u32 m0, s31, 0
    s_add_u32 s32, s30, 0
    buffer_load_dwordx4 v5, s[12:15], s32 offen sc1 lds
    s_add_u32 m0, s31, 4096
    s_add_u32 s32, s30, 4096
    buffer_load_dwordx4 v5, s[12:15], s32 offen sc1 lds
    s_add_u32 m0, s31, 8192
    s_add_u32 s32, s30, 8192
    buffer_load_dwordx4 v5, s[12:15], s32 offen sc1 lds
    s_add_u32 m0, s31, 12288
    s_add_u32 s32, s30, 12288
    buffer_load_dwordx4 v5, s[12:15], s32 offen sc1 lds
    s_add_u32 m0, s31, 16384
    s_add_u32 s32, s30, 16384
    buffer_load_dwordx4 v5, s[12:15], s32 offen sc1 lds
    s_add_u32 m0, s31, 20480
    s_add_u32 s32, s30, 20480
    buffer_load_dwordx4 v5, s[12:15], s32 offen sc1 lds
    s_add_u32 m0, s31, 24576
    s_add_u32 s32, s30, 24576
    buffer_load_dwordx4 v5, s[12:15], s32 offen sc1 lds
    s_waitcnt vmcnt(2)
    s_barrier
    s_add_u32 m0, s31, 28672
    s_add_u32 s32, s30, 28672
    buffer_load_dwordx4 v5, s[12:15], s32 offen sc1 lds
    s_add_u32 m0, s31, 32768
    s_add_u32 s32, s30, 32768
    buffer_load_dwordx4 v5, s[12:15], s32 offen sc1 lds
    s_add_u32 m0, s31, 36864
    s_add_u32 s32, s30, 36864
    buffer_load_dwordx4 v5, s[12:15], s32 offen sc1 lds
    s_add_u32 m0, s31, 40960
    s_add_u32 s32, s30, 40960
    buffer_load_dwordx4 v5, s[12:15], s32 offen sc1 lds
    s_add_u32 m0, s31, 45056
    s_add_u32 s32, s30, 45056
    buffer_load_dwordx4 v5, s[12:15], s32 offen sc1 lds
    s_add_u32 m0, s31, 49152
    s_add_u32 s32, s30, 49152
    buffer_load_dwordx4 v5, s[12:15], s32 offen sc1 lds
    s_add_u32 m0, s31, 53248
    s_add_u32 s32, s30, 53248
    buffer_load_dwordx4 v5, s[12:15], s32 offen sc1 lds
    s_add_u32 m0, s31, 57344
    s_add_u32 s32, s30, 57344
    buffer_load_dwordx4 v5, s[12:15], s32 offen sc1 lds
    s_add_u32 m0, s31, 61440
    s_add_u32 s32, s30, 61440
    buffer_load_dwordx4 v5, s[12:15], s32 offen sc1 lds
    s_add_u32 m0, s31, 65536
    s_add_u32 s32, s30, 65536
    buffer_load_dwordx4 v5, s[12:15], s32 offen sc1 lds
    s_add_u32 m0, s31, 69632
    s_add_u32 s32, s30, 69632
    buffer_load_dwordx4 v5, s[12:15], s32 offen sc1 lds
    s_add_u32 m0, s31, 73728
    s_add_u32 s32, s30, 73728
    buffer_load_dwordx4 v5, s[12:15], s32 offen sc1 lds
    s_add_u32 m0, s31, 77824
    s_add_u32 s32, s30, 77824
    buffer_load_dwordx4 v5, s[12:15], s32 offen sc1 lds
    s_add_u32 m0, s31, 81920
    s_add_u32 s32, s30, 81920
    buffer_load_dwordx4 v5, s[12:15], s32 offen sc1 lds
    s_add_u32 m0, s31, 86016
    s_add_u32 s32, s30, 86016
    buffer_load_dwordx4 v5, s[12:15], s32 offen sc1 lds
    s_add_u32 m0, s31, 90112
    s_add_u32 s32, s30, 90112
    buffer_load_dwordx4 v5, s[12:15], s32 offen sc1 lds
    s_add_u32 m0, s31, 94208
    s_add_u32 s32, s30, 94208
    buffer_load_dwordx4 v5, s[12:15], s32 offen sc1 lds
    s_add_u32 m0, s31, 98304
    s_add_u32 s32, s30, 98304
    buffer_load_dwordx4 v5, s[12:15], s32 offen sc1 lds
    s_add_u32 m0, s31, 102400
    s_add_u32 s32, s30, 102400
    buffer_load_dwordx4 v5, s[12:15], s32 offen sc1 lds
    s_add_u32 m0, s31, 106496
    s_add_u32 s32, s30, 106496
    buffer_load_dwordx4 v5, s[12:15], s32 offen sc1 lds
    s_add_u32 m0, s31, 110592
    s_add_u32 s32, s30, 110592
    buffer_load_dwordx4 v5, s[12:15], s32 offen sc1 lds
    s_add_u32 m0, s31, 114688
    s_add_u32 s32, s30, 114688
    buffer_load_dwordx4 v5, s[12:15], s32 offen sc1 lds
    s_add_u32 m0, s31, 118784
    s_add_u32 s32, s30, 118784
    buffer_load_dwordx4 v5, s[12:15], s32 offen sc1 lds
    s_add_u32 m0, s31, 122880
    s_add_u32 s32, s30, 122880
    buffer_load_dwordx4 v5, s[12:15], s32 offen sc1 lds
    s_add_u32 m0, s31, 126976
    s_add_u32 s32, s30, 126976
    buffer_load_dwordx4 v5, s[12:15], s32 offen sc1 lds
    s_add_u32 m0, s31, 131072
    s_add_u32 s32, s30, 131072
    buffer_load_dwordx4 v5, s[12:15], s32 offen sc1 lds
    s_add_u32 m0, s31, 135168
    s_add_u32 s32, s30, 135168
    buffer_load_dwordx4 v5, s[12:15], s32 offen sc1 lds
    s_add_u32 m0, s31, 139264
    s_add_u32 s32, s30, 139264
    buffer_load_dwordx4 v5, s[12:15], s32 offen sc1 lds
    s_add_u32 m0, s31, 143360
    s_add_u32 s32, s30, 143360
    buffer_load_dwordx4 v5, s[12:15], s32 offen sc1 lds
    s_add_u32 m0, s31, 147456
    s_add_u32 s32, s30, 147456
    buffer_load_dwordx4 v5, s[12:15], s32 offen sc1 lds
    s_add_u32 m0, s31, 151552
    s_add_u32 s32, s30, 151552
    buffer_load_dwordx4 v5, s[12:15], s32 offen sc1 lds
    s_add_u32 m0, s31, 155648
    s_add_u32 s32, s30, 155648
    buffer_load_dwordx4 v5, s[12:15], s32 offen sc1 lds
    s_add_u32 m0, s31, 159744
    s_add_u32 s32, s30, 159744
    buffer_load_dwordx4 v5, s[12:15], s32 offen sc1 lds
    s_load_dwordx2 s[4:5], s[0:1], 32
    s_load_dwordx2 s[6:7], s[0:1], 48
    s_waitcnt vmcnt(30)
    s_barrier
    s_waitcnt vmcnt(0)
    s_barrier
    s_setprio 0
    s_cmp_lg_u32 s60, 0
    s_cbranch_scc1 wo_loader
    s_sub_u32 s26, s26, 4
    v_lshlrev_b32 v3, 4, v2
    v_lshrrev_b32 v4, 3, v2
    v_and_b32 v5, 7, v2
    v_lshlrev_b32 v5, 4, v5
    v_mul_u32_u24 v6, 196608, v4
    v_add_u32 v6, v6, v5
    v_lshl_add_u32 v5, v4, 18, v5
    s_mul_i32 s27, s2, 24576
    s_mul_i32 s28, s26, 6144
    s_add_u32 s27, s27, s28
    s_lshl_b32 s28, s2, 10
    s_lshl_b32 s29, s26, 8
    s_add_u32 s28, s28, s29
    s_mul_i32 s33, s2, 24576
    s_lshl_b32 s29, s26, 10
    s_add_u32 s33, s33, s29
    s_mul_i32 s29, s2, 768
    s_mul_i32 s30, s26, 1572864
    s_add_u32 s29, s29, s30
    s_waitcnt lgkmcnt(0)
    s_mov_b32 s12, s4
    s_mov_b32 s13, s5
    s_mov_b32 s14, 6291456
    s_mov_b32 s15, 0x20000
    s_mov_b32 s16, s6
    s_mov_b32 s17, s7
    s_mov_b32 s18, 6291456
    s_mov_b32 s19, 0x20000
    s_add_u32 s20, s8, 18874368
    s_addc_u32 s21, s9, 0
    s_mov_b32 s22, 6291456
    s_mov_b32 s23, 0x20000
    s_add_u32 s40, s8, 25165824
    s_addc_u32 s41, s9, 0
    s_mov_b32 s42, 6291456
    s_mov_b32 s43, 0x20000
    s_add_u32 s30, s27, 0
    buffer_load_dwordx4 v[8:11], v3, s[12:15], s30 offen
    s_add_u32 s30, s27, 1024
    buffer_load_dwordx4 v[12:15], v3, s[12:15], s30 offen
    s_add_u32 s30, s27, 2048
    buffer_load_dwordx4 v[16:19], v3, s[12:15], s30 offen
    s_add_u32 s30, s27, 3072
    buffer_load_dwordx4 v[20:23], v3, s[12:15], s30 offen
    s_add_u32 s30, s27, 4096
    buffer_load_dwordx4 v[24:27], v3, s[12:15], s30 offen
    s_add_u32 s30, s27, 5120
    buffer_load_dwordx4 v[28:31], v3, s[12:15], s30 offen
    s_add_u32 s30, s33, 0
    buffer_load_dwordx4 v[32:35], v3, s[16:19], s30 offen
    s_add_u32 s30, s33, 4096
    buffer_load_dwordx4 v[36:39], v3, s[16:19], s30 offen
    s_add_u32 s30, s33, 8192
    buffer_load_dwordx4 v[40:43], v3, s[16:19], s30 offen
    s_add_u32 s30, s33, 12288
    buffer_load_dwordx4 v[44:47], v3, s[16:19], s30 offen
    s_add_u32 s30, s33, 16384
    buffer_load_dwordx4 v[48:51], v3, s[16:19], s30 offen
    s_add_u32 s30, s33, 20480
    buffer_load_dwordx4 v[52:55], v3, s[16:19], s30 offen
    s_waitcnt vmcnt(0)
    s_add_u32 s30, s28, 0
    buffer_store_dwordx4 v[8:11], v5, s[20:23], s30 offen sc0 sc1
    s_add_u32 s30, s28, 2097152
    buffer_store_dwordx4 v[12:15], v5, s[20:23], s30 offen sc0 sc1
    s_add_u32 s30, s28, 4194304
    buffer_store_dwordx4 v[16:19], v5, s[20:23], s30 offen sc0 sc1
    s_add_u32 s30, s28, 128
    buffer_store_dwordx4 v[20:23], v5, s[20:23], s30 offen sc0 sc1
    s_add_u32 s30, s28, 2097280
    buffer_store_dwordx4 v[24:27], v5, s[20:23], s30 offen sc0 sc1
    s_add_u32 s30, s28, 4194432
    buffer_store_dwordx4 v[28:31], v5, s[20:23], s30 offen sc0 sc1
    s_add_u32 s30, s29, 0
    buffer_store_dwordx4 v[32:35], v6, s[40:43], s30 offen sc0 sc1
    s_add_u32 s30, s29, 128
    buffer_store_dwordx4 v[36:39], v6, s[40:43], s30 offen sc0 sc1
    s_add_u32 s30, s29, 256
    buffer_store_dwordx4 v[40:43], v6, s[40:43], s30 offen sc0 sc1
    s_add_u32 s30, s29, 384
    buffer_store_dwordx4 v[44:47], v6, s[40:43], s30 offen sc0 sc1
    s_add_u32 s30, s29, 512
    buffer_store_dwordx4 v[48:51], v6, s[40:43], s30 offen sc0 sc1
    s_add_u32 s30, s29, 640
    buffer_store_dwordx4 v[52:55], v6, s[40:43], s30 offen sc0 sc1
    s_add_u32 s26, s26, 4
    s_branch wo_loader
att_end:
    s_endpgm
att_cmp:
    v_and_b32 v3, 31, v2
    v_lshrrev_b32 v4, 5, v2
    v_lshlrev_b32 v170, 3, v2
    v_lshlrev_b32 v171, 3, v3
    v_add_u32 v171, 8192, v171
    s_mul_i32 s27, s24, 81920
    s_mul_i32 s28, s25, 10240
    s_add_u32 s27, s27, s28
    s_lshl_b32 s29, s26, 9
    s_add_u32 s29, s29, s27
    s_lshl_b32 s28, s26, 11
    s_add_u32 s27, s27, s28
    buffer_load_dwordx2 v[8:9], v170, s[12:15], s27 offen sc1
    buffer_load_dwordx2 v[10:11], v170, s[12:15], s27 offen offset:512 sc1
    buffer_load_dwordx2 v[12:13], v170, s[12:15], s27 offen offset:1024 sc1
    buffer_load_dwordx2 v[14:15], v170, s[12:15], s27 offen offset:1536 sc1
    buffer_load_dwordx2 v[16:17], v171, s[12:15], s29 offen sc1
    buffer_load_dwordx2 v[18:19], v171, s[12:15], s29 offen offset:256 sc1
    v_mul_u32_u24 v172, 320, v4
    v_lshl_add_u32 v172, v3, 4, v172
    v_add_u32 v172, 10240, v172
    s_mov_b32 s34, 0x000fffff
    s_mov_b32 s35, 0x000fffff
    s_mov_b32 s37, 0
    s_mov_b32 s40, 0
    v_cmp_eq_u32 vcc, 20, v3
    v_mov_b32 v6, 0x3f803f80
    s_nop 0
    v_cndmask_b32 v148, 0, v6, vcc
    v_cndmask_b32 v149, 0, v6, vcc
    v_cndmask_b32 v150, 0, v6, vcc
    v_cndmask_b32 v151, 0, v6, vcc
    v_cndmask_b32 v152, 0, v6, vcc
    v_cndmask_b32 v153, 0, v6, vcc
    v_cndmask_b32 v154, 0, v6, vcc
    v_cndmask_b32 v155, 0, v6, vcc
    v_cndmask_b32 v156, 0, v6, vcc
    v_cndmask_b32 v157, 0, v6, vcc
    v_cndmask_b32 v158, 0, v6, vcc
    v_cndmask_b32 v159, 0, v6, vcc
    v_cndmask_b32 v160, 0, v6, vcc
    v_cndmask_b32 v161, 0, v6, vcc
    v_cndmask_b32 v162, 0, v6, vcc
    v_cndmask_b32 v163, 0, v6, vcc
    s_lshl_b32 s27, s25, 4
    s_lshl_b32 s28, s26, 2
    s_add_u32 s27, s27, s28
    v_lshrrev_b32 v24, 4, v2
    v_add_u32 v24, s27, v24
    v_mul_u32_u24 v24, 20480, v24
    v_and_b32 v25, 15, v2
    v_lshl_add_u32 v20, v25, 4, v24
    s_mul_i32 s28, s24, 5
    s_lshr_b32 s28, s28, 1
    s_add_u32 s29, s28, 0
    s_lshr_b32 s30, s29, 2
    s_lshl_b32 s30, s30, 10
    s_and_b32 s29, s29, 3
    s_lshl_b32 s29, s29, 8
    s_add_u32 s61, s29, s30
    s_add_u32 s61, s61, 7864320
    s_add_u32 s29, s28, 1
    s_lshr_b32 s30, s29, 2
    s_lshl_b32 s30, s30, 10
    s_and_b32 s29, s29, 3
    s_lshl_b32 s29, s29, 8
    s_add_u32 s62, s29, s30
    s_add_u32 s62, s62, 7864320
    s_add_u32 s29, s28, 2
    s_lshr_b32 s30, s29, 2
    s_lshl_b32 s30, s30, 10
    s_and_b32 s29, s29, 3
    s_lshl_b32 s29, s29, 8
    s_add_u32 s63, s29, s30
    s_add_u32 s63, s63, 7864320
    s_waitcnt vmcnt(0)
    v_cmp_gt_u32 vcc, 32, v2
    s_nop 1
    v_cndmask_b32 v16, 0, v16, vcc
    v_cndmask_b32 v17, 0, v17, vcc
    v_cndmask_b32 v18, 0, v18, vcc
    v_cndmask_b32 v19, 0, v19, vcc
    s_barrier
    ds_read2st64_b64 v[136:139], v170 offset1:1
    ds_read_b64 v[144:145], v171
    s_waitcnt lgkmcnt(0)
    v_mfma_f32_32x32x16_bf16 v[64:79], v[136:139], v[8:11], 0
    v_mfma_f32_32x32x16_bf16 v[80:95], v[136:139], v[12:15], 0
    v_mfma_f32_32x32x8_bf16 v[64:79], v[144:145], v[16:17], v[64:79]
    v_mfma_f32_32x32x8_bf16 v[80:95], v[144:145], v[18:19], v[80:95]
    s_nop 10
    v_max3_f32 v6, v64, v65, v66
    v_max3_f32 v6, v6, v67, v68
    v_max3_f32 v6, v6, v69, v70
    v_max3_f32 v6, v6, v71, v72
    v_max3_f32 v6, v6, v73, v74
    v_max3_f32 v6, v6, v75, v76
    v_max3_f32 v6, v6, v77, v78
    v_max_f32 v6, v6, v79
    v_max3_f32 v7, v80, v81, v82
    v_max3_f32 v7, v7, v83, v84
    v_max3_f32 v7, v7, v85, v86
    v_max3_f32 v7, v7, v87, v88
    v_max3_f32 v7, v7, v89, v90
    v_max3_f32 v7, v7, v91, v92
    v_max3_f32 v7, v7, v93, v94
    v_max_f32 v7, v7, v95
att_setmax:
    ds_read2st64_b64 v[136:139], v170 offset1:1
    ds_read_b64 v[144:145], v171
    s_mov_b64 exec, s[34:35]
    ds_read_b128 v[148:151], v172
    ds_read_b128 v[152:155], v172 offset:640
    ds_read_b128 v[160:163], v172 offset:640
    s_mov_b64 exec, -1
    v_mov_b32 v28, v6
    v_mov_b32 v29, v7
    s_nop 0
    v_permlane32_swap_b32 v6, v28
    v_permlane32_swap_b32 v7, v29
    v_max_f32 v6, v6, v28
    v_max_f32 v7, v7, v29
    v_sub_f32 v32, 0, v6
    v_sub_f32 v33, 0, v6
    v_sub_f32 v34, 0, v6
    v_sub_f32 v35, 0, v6
    v_sub_f32 v36, 0, v6
    v_sub_f32 v37, 0, v6
    v_sub_f32 v38, 0, v6
    v_sub_f32 v39, 0, v6
    v_sub_f32 v40, 0, v6
    v_sub_f32 v41, 0, v6
    v_sub_f32 v42, 0, v6
    v_sub_f32 v43, 0, v6
    v_sub_f32 v44, 0, v6
    v_sub_f32 v45, 0, v6
    v_sub_f32 v46, 0, v6
    v_sub_f32 v47, 0, v6
    v_sub_f32 v48, 0, v7
    v_sub_f32 v49, 0, v7
    v_sub_f32 v50, 0, v7
    v_sub_f32 v51, 0, v7
    v_sub_f32 v52, 0, v7
    v_sub_f32 v53, 0, v7
    v_sub_f32 v54, 0, v7
    v_sub_f32 v55, 0, v7
    v_sub_f32 v56, 0, v7
    v_sub_f32 v57, 0, v7
    v_sub_f32 v58, 0, v7
    v_sub_f32 v59, 0, v7
    v_sub_f32 v60, 0, v7
    v_sub_f32 v61, 0, v7
    v_sub_f32 v62, 0, v7
    v_sub_f32 v63, 0, v7
    v_mov_b32 v96, 0
    v_mov_b32 v97, 0
    v_mov_b32 v98, 0
    v_mov_b32 v99, 0
    v_mov_b32 v100, 0
    v_mov_b32 v101, 0
    v_mov_b32 v102, 0
    v_mov_b32 v103, 0
    v_mov_b32 v104, 0
    v_mov_b32 v105, 0
    v_mov_b32 v106, 0
    v_mov_b32 v107, 0
    v_mov_b32 v108, 0
    v_mov_b32 v109, 0
    v_mov_b32 v110, 0
    v_mov_b32 v111, 0
    v_mov_b32 v112, 0
    v_mov_b32 v113, 0
    v_mov_b32 v114, 0
    v_mov_b32 v115, 0
    v_mov_b32 v116, 0
    v_mov_b32 v117, 0
    v_mov_b32 v118, 0
    v_mov_b32 v119, 0
    v_mov_b32 v120, 0
    v_mov_b32 v121, 0
    v_mov_b32 v122, 0
    v_mov_b32 v123, 0
    v_mov_b32 v124, 0
    v_mov_b32 v125, 0
    v_mov_b32 v126, 0
    v_mov_b32 v127, 0
    v_mov_b32 v132, 0
    v_mov_b32 v133, 0
    v_mov_b32 v134, 0
    v_mov_b32 v135, 0
    s_mov_b32 s38, 0
    s_waitcnt lgkmcnt(0)
    v_mfma_f32_32x32x16_bf16 v[64:79], v[136:139], v[8:11], v[32:47]
    v_mfma_f32_32x32x8_bf16 v[64:79], v[144:145], v[16:17], v[64:79]
att_loop:
    s_add_u32 s39, s38, 20480
    s_cmp_eq_u32 s39, 163840
    s_cselect_b32 s39, 0, s39
    v_add_u32 v164, s38, v170
    v_add_u32 v165, s38, v171
    v_add_u32 v166, s38, v172
    v_add_u32 v167, s39, v170
    v_add_u32 v168, s39, v171
    v_add_u32 v169, s39, v172
    v_mfma_f32_32x32x16_bf16 v[80:95], v[136:139], v[12:15], v[48:63]
    ds_read2st64_b64 v[140:143], v164 offset0:2 offset1:3
    ds_read_b64 v[146:147], v165 offset:256
    v_exp_f32 v64, v64
    v_exp_f32 v65, v65
    v_exp_f32 v66, v66
    v_exp_f32 v67, v67
    v_exp_f32 v68, v68
    v_mfma_f32_32x32x16_bf16 v[112:127], v[160:163], v[132:135], v[112:127]
    v_exp_f32 v69, v69
    v_exp_f32 v70, v70
    v_exp_f32 v71, v71
    v_exp_f32 v72, v72
    v_cvt_pk_bf16_f32 v128, v64, v65
    v_cvt_pk_bf16_f32 v129, v66, v67
    v_mfma_f32_32x32x8_bf16 v[80:95], v[144:145], v[18:19], v[80:95]
    v_cvt_pk_bf16_f32 v130, v68, v69
    v_cvt_pk_bf16_f32 v131, v70, v71
    v_exp_f32 v73, v73
    v_exp_f32 v74, v74
    v_exp_f32 v75, v75
    v_exp_f32 v76, v76
    s_waitcnt lgkmcnt(2)
    v_mfma_f32_32x32x16_bf16 v[96:111], v[148:151], v[128:131], v[96:111]
    v_exp_f32 v77, v77
    v_exp_f32 v78, v78
    v_exp_f32 v79, v79
    v_cvt_pk_bf16_f32 v132, v72, v73
    v_cvt_pk_bf16_f32 v133, v74, v75
    v_cvt_pk_bf16_f32 v134, v76, v77
    v_cvt_pk_bf16_f32 v135, v78, v79
    s_waitcnt lgkmcnt(0)
    v_mfma_f32_32x32x16_bf16 v[64:79], v[140:143], v[8:11], v[32:47]
    s_mov_b64 exec, s[34:35]
    ds_read_b128 v[156:159], v166 offset:1280
    ds_read_b128 v[160:163], v166 offset:1920
    s_mov_b64 exec, -1
    v_exp_f32 v80, v80
    v_exp_f32 v81, v81
    v_exp_f32 v82, v82
    v_exp_f32 v83, v83
    v_exp_f32 v84, v84
    v_mfma_f32_32x32x16_bf16 v[96:111], v[152:155], v[132:135], v[96:111]
    v_exp_f32 v85, v85
    v_exp_f32 v86, v86
    v_exp_f32 v87, v87
    v_exp_f32 v88, v88
    v_cvt_pk_bf16_f32 v128, v80, v81
    v_cvt_pk_bf16_f32 v129, v82, v83
    v_mfma_f32_32x32x8_bf16 v[64:79], v[146:147], v[16:17], v[64:79]
    v_cvt_pk_bf16_f32 v130, v84, v85
    v_cvt_pk_bf16_f32 v131, v86, v87
    v_exp_f32 v89, v89
    v_exp_f32 v90, v90
    v_exp_f32 v91, v91
    v_exp_f32 v92, v92
    v_mfma_f32_32x32x16_bf16 v[112:127], v[148:151], v[128:131], v[112:127]
    v_exp_f32 v93, v93
    v_exp_f32 v94, v94
    v_exp_f32 v95, v95
    v_cvt_pk_bf16_f32 v132, v88, v89
    v_cvt_pk_bf16_f32 v133, v90, v91
    v_cvt_pk_bf16_f32 v134, v92, v93
    v_cvt_pk_bf16_f32 v135, v94, v95
    v_mfma_f32_32x32x16_bf16 v[80:95], v[140:143], v[12:15], v[48:63]
    ds_read2st64_b64 v[136:139], v164 offset0:4 offset1:5
    ds_read_b64 v[144:145], v165 offset:512
    v_exp_f32 v64, v64
    v_exp_f32 v65, v65
    v_exp_f32 v66, v66
    v_exp_f32 v67, v67
    v_exp_f32 v68, v68
    v_mfma_f32_32x32x16_bf16 v[112:127], v[152:155], v[132:135], v[112:127]
    v_exp_f32 v69, v69
    v_exp_f32 v70, v70
    v_exp_f32 v71, v71
    v_exp_f32 v72, v72
    v_cvt_pk_bf16_f32 v128, v64, v65
    v_cvt_pk_bf16_f32 v129, v66, v67
    v_mfma_f32_32x32x8_bf16 v[80:95], v[146:147], v[18:19], v[80:95]
    v_cvt_pk_bf16_f32 v130, v68, v69
    v_cvt_pk_bf16_f32 v131, v70, v71
    v_exp_f32 v73, v73
    v_exp_f32 v74, v74
    v_exp_f32 v75, v75
    v_exp_f32 v76, v76
    s_waitcnt lgkmcnt(2)
    v_mfma_f32_32x32x16_bf16 v[96:111], v[156:159], v[128:131], v[96:111]
    v_exp_f32 v77, v77
    v_exp_f32 v78, v78
    v_exp_f32 v79, v79
    v_cvt_pk_bf16_f32 v132, v72, v73
    v_cvt_pk_bf16_f32 v133, v74, v75
    v_cvt_pk_bf16_f32 v134, v76, v77
    v_cvt_pk_bf16_f32 v135, v78, v79
    s_waitcnt lgkmcnt(0)
    v_mfma_f32_32x32x16_bf16 v[64:79], v[136:139], v[8:11], v[32:47]
    s_mov_b64 exec, s[34:35]
    ds_read_b128 v[148:151], v166 offset:2560
    ds_read_b128 v[152:155], v166 offset:3200
    s_mov_b64 exec, -1
    v_exp_f32 v80, v80
    v_exp_f32 v81, v81
    v_exp_f32 v82, v82
    v_exp_f32 v83, v83
    v_exp_f32 v84, v84
    v_mfma_f32_32x32x16_bf16 v[96:111], v[160:163], v[132:135], v[96:111]
    v_exp_f32 v85, v85
    v_exp_f32 v86, v86
    v_exp_f32 v87, v87
    v_exp_f32 v88, v88
    v_cvt_pk_bf16_f32 v128, v80, v81
    v_cvt_pk_bf16_f32 v129, v82, v83
    v_mfma_f32_32x32x8_bf16 v[64:79], v[144:145], v[16:17], v[64:79]
    v_cvt_pk_bf16_f32 v130, v84, v85
    v_cvt_pk_bf16_f32 v131, v86, v87
    v_exp_f32 v89, v89
    v_exp_f32 v90, v90
    v_exp_f32 v91, v91
    v_exp_f32 v92, v92
    v_mfma_f32_32x32x16_bf16 v[112:127], v[156:159], v[128:131], v[112:127]
    v_exp_f32 v93, v93
    v_exp_f32 v94, v94
    v_exp_f32 v95, v95
    v_cvt_pk_bf16_f32 v132, v88, v89
    v_cvt_pk_bf16_f32 v133, v90, v91
    v_cvt_pk_bf16_f32 v134, v92, v93
    v_cvt_pk_bf16_f32 v135, v94, v95
    v_mfma_f32_32x32x16_bf16 v[80:95], v[136:139], v[12:15], v[48:63]
    ds_read2st64_b64 v[140:143], v164 offset0:6 offset1:7
    ds_read_b64 v[146:147], v165 offset:768
    v_exp_f32 v64, v64
    v_exp_f32 v65, v65
    v_exp_f32 v66, v66
    v_exp_f32 v67, v67
    v_exp_f32 v68, v68
    v_mfma_f32_32x32x16_bf16 v[112:127], v[160:163], v[132:135], v[112:127]
    v_exp_f32 v69, v69
    v_exp_f32 v70, v70
    v_exp_f32 v71, v71
    v_exp_f32 v72, v72
    v_cvt_pk_bf16_f32 v128, v64, v65
    v_cvt_pk_bf16_f32 v129, v66, v67
    v_mfma_f32_32x32x8_bf16 v[80:95], v[144:145], v[18:19], v[80:95]
    v_cvt_pk_bf16_f32 v130, v68, v69
    v_cvt_pk_bf16_f32 v131, v70, v71
    v_exp_f32 v73, v73
    v_exp_f32 v74, v74
    v_exp_f32 v75, v75
    v_exp_f32 v76, v76
    s_waitcnt lgkmcnt(2)
    v_mfma_f32_32x32x16_bf16 v[96:111], v[148:151], v[128:131], v[96:111]
    v_exp_f32 v77, v77
    v_exp_f32 v78, v78
    v_exp_f32 v79, v79
    v_cvt_pk_bf16_f32 v132, v72, v73
    v_cvt_pk_bf16_f32 v133, v74, v75
    v_cvt_pk_bf16_f32 v134, v76, v77
    v_cvt_pk_bf16_f32 v135, v78, v79
    s_waitcnt lgkmcnt(0)
    v_mfma_f32_32x32x16_bf16 v[64:79], v[140:143], v[8:11], v[32:47]
    s_mov_b64 exec, s[34:35]
    ds_read_b128 v[156:159], v166 offset:3840
    ds_read_b128 v[160:163], v166 offset:4480
    s_mov_b64 exec, -1
    v_exp_f32 v80, v80
    v_exp_f32 v81, v81
    v_exp_f32 v82, v82
    v_exp_f32 v83, v83
    v_exp_f32 v84, v84
    v_mfma_f32_32x32x16_bf16 v[96:111], v[152:155], v[132:135], v[96:111]
    v_exp_f32 v85, v85
    v_exp_f32 v86, v86
    v_exp_f32 v87, v87
    v_exp_f32 v88, v88
    v_cvt_pk_bf16_f32 v128, v80, v81
    v_cvt_pk_bf16_f32 v129, v82, v83
    v_mfma_f32_32x32x8_bf16 v[64:79], v[146:147], v[16:17], v[64:79]
    v_cvt_pk_bf16_f32 v130, v84, v85
    v_cvt_pk_bf16_f32 v131, v86, v87
    v_exp_f32 v89, v89
    v_exp_f32 v90, v90
    v_exp_f32 v91, v91
    v_exp_f32 v92, v92
    v_mfma_f32_32x32x16_bf16 v[112:127], v[148:151], v[128:131], v[112:127]
    v_exp_f32 v93, v93
    v_exp_f32 v94, v94
    v_exp_f32 v95, v95
    v_cvt_pk_bf16_f32 v132, v88, v89
    v_cvt_pk_bf16_f32 v133, v90, v91
    v_cvt_pk_bf16_f32 v134, v92, v93
    v_cvt_pk_bf16_f32 v135, v94, v95
    v_mfma_f32_32x32x16_bf16 v[80:95], v[140:143], v[12:15], v[48:63]
    ds_read2st64_b64 v[136:139], v164 offset0:8 offset1:9
    ds_read_b64 v[144:145], v165 offset:1024
    v_exp_f32 v64, v64
    v_exp_f32 v65, v65
    v_exp_f32 v66, v66
    v_exp_f32 v67, v67
    v_exp_f32 v68, v68
    v_mfma_f32_32x32x16_bf16 v[112:127], v[152:155], v[132:135], v[112:127]
    v_exp_f32 v69, v69
    v_exp_f32 v70, v70
    v_exp_f32 v71, v71
    v_exp_f32 v72, v72
    v_cvt_pk_bf16_f32 v128, v64, v65
    v_cvt_pk_bf16_f32 v129, v66, v67
    v_mfma_f32_32x32x8_bf16 v[80:95], v[146:147], v[18:19], v[80:95]
    v_cvt_pk_bf16_f32 v130, v68, v69
    v_cvt_pk_bf16_f32 v131, v70, v71
    v_exp_f32 v73, v73
    v_exp_f32 v74, v74
    v_exp_f32 v75, v75
    v_exp_f32 v76, v76
    s_waitcnt lgkmcnt(2)
    v_mfma_f32_32x32x16_bf16 v[96:111], v[156:159], v[128:131], v[96:111]
    v_exp_f32 v77, v77
    v_exp_f32 v78, v78
    v_exp_f32 v79, v79
    v_cvt_pk_bf16_f32 v132, v72, v73
    v_cvt_pk_bf16_f32 v133, v74, v75
    v_cvt_pk_bf16_f32 v134, v76, v77
    v_cvt_pk_bf16_f32 v135, v78, v79
    s_waitcnt lgkmcnt(0)
    v_mfma_f32_32x32x16_bf16 v[64:79], v[136:139], v[8:11], v[32:47]
    s_mov_b64 exec, s[34:35]
    ds_read_b128 v[148:151], v166 offset:5120
    ds_read_b128 v[152:155], v166 offset:5760
    s_mov_b64 exec, -1
    v_exp_f32 v80, v80
    v_exp_f32 v81, v81
    v_exp_f32 v82, v82
    v_exp_f32 v83, v83
    v_exp_f32 v84, v84
    v_mfma_f32_32x32x16_bf16 v[96:111], v[160:163], v[132:135], v[96:111]
    v_exp_f32 v85, v85
    v_exp_f32 v86, v86
    v_exp_f32 v87, v87
    v_exp_f32 v88, v88
    v_cvt_pk_bf16_f32 v128, v80, v81
    v_cvt_pk_bf16_f32 v129, v82, v83
    v_mfma_f32_32x32x8_bf16 v[64:79], v[144:145], v[16:17], v[64:79]
    v_cvt_pk_bf16_f32 v130, v84, v85
    v_cvt_pk_bf16_f32 v131, v86, v87
    v_exp_f32 v89, v89
    v_exp_f32 v90, v90
    v_exp_f32 v91, v91
    v_exp_f32 v92, v92
    v_mfma_f32_32x32x16_bf16 v[112:127], v[156:159], v[128:131], v[112:127]
    v_exp_f32 v93, v93
    v_exp_f32 v94, v94
    v_exp_f32 v95, v95
    v_cvt_pk_bf16_f32 v132, v88, v89
    v_cvt_pk_bf16_f32 v133, v90, v91
    v_cvt_pk_bf16_f32 v134, v92, v93
    v_cvt_pk_bf16_f32 v135, v94, v95
    v_mfma_f32_32x32x16_bf16 v[80:95], v[136:139], v[12:15], v[48:63]
    ds_read2st64_b64 v[140:143], v164 offset0:10 offset1:11
    ds_read_b64 v[146:147], v165 offset:1280
    v_exp_f32 v64, v64
    v_exp_f32 v65, v65
    v_exp_f32 v66, v66
    v_exp_f32 v67, v67
    v_exp_f32 v68, v68
    v_mfma_f32_32x32x16_bf16 v[112:127], v[160:163], v[132:135], v[112:127]
    v_exp_f32 v69, v69
    v_exp_f32 v70, v70
    v_exp_f32 v71, v71
    v_exp_f32 v72, v72
    v_cvt_pk_bf16_f32 v128, v64, v65
    v_cvt_pk_bf16_f32 v129, v66, v67
    v_mfma_f32_32x32x8_bf16 v[80:95], v[144:145], v[18:19], v[80:95]
    v_cvt_pk_bf16_f32 v130, v68, v69
    v_cvt_pk_bf16_f32 v131, v70, v71
    v_exp_f32 v73, v73
    v_exp_f32 v74, v74
    v_exp_f32 v75, v75
    v_exp_f32 v76, v76
    s_waitcnt lgkmcnt(2)
    v_mfma_f32_32x32x16_bf16 v[96:111], v[148:151], v[128:131], v[96:111]
    v_exp_f32 v77, v77
    v_exp_f32 v78, v78
    v_exp_f32 v79, v79
    v_cvt_pk_bf16_f32 v132, v72, v73
    v_cvt_pk_bf16_f32 v133, v74, v75
    v_cvt_pk_bf16_f32 v134, v76, v77
    v_cvt_pk_bf16_f32 v135, v78, v79
    s_waitcnt lgkmcnt(0)
    v_mfma_f32_32x32x16_bf16 v[64:79], v[140:143], v[8:11], v[32:47]
    s_mov_b64 exec, s[34:35]
    ds_read_b128 v[156:159], v166 offset:6400
    ds_read_b128 v[160:163], v166 offset:7040
    s_mov_b64 exec, -1
    v_exp_f32 v80, v80
    v_exp_f32 v81, v81
    v_exp_f32 v82, v82
    v_exp_f32 v83, v83
    v_exp_f32 v84, v84
    v_mfma_f32_32x32x16_bf16 v[96:111], v[152:155], v[132:135], v[96:111]
    v_exp_f32 v85, v85
    v_exp_f32 v86, v86
    v_exp_f32 v87, v87
    v_exp_f32 v88, v88
    v_cvt_pk_bf16_f32 v128, v80, v81
    v_cvt_pk_bf16_f32 v129, v82, v83
    v_mfma_f32_32x32x8_bf16 v[64:79], v[146:147], v[16:17], v[64:79]
    v_cvt_pk_bf16_f32 v130, v84, v85
    v_cvt_pk_bf16_f32 v131, v86, v87
    v_exp_f32 v89, v89
    v_exp_f32 v90, v90
    v_exp_f32 v91, v91
    v_exp_f32 v92, v92
    v_mfma_f32_32x32x16_bf16 v[112:127], v[148:151], v[128:131], v[112:127]
    v_exp_f32 v93, v93
    v_exp_f32 v94, v94
    v_exp_f32 v95, v95
    v_cvt_pk_bf16_f32 v132, v88, v89
    v_cvt_pk_bf16_f32 v133, v90, v91
    v_cvt_pk_bf16_f32 v134, v92, v93
    v_cvt_pk_bf16_f32 v135, v94, v95
    v_mfma_f32_32x32x16_bf16 v[80:95], v[140:143], v[12:15], v[48:63]
    ds_read2st64_b64 v[136:139], v164 offset0:12 offset1:13
    ds_read_b64 v[144:145], v165 offset:1536
    v_exp_f32 v64, v64
    v_exp_f32 v65, v65
    v_exp_f32 v66, v66
    v_exp_f32 v67, v67
    v_exp_f32 v68, v68
    v_mfma_f32_32x32x16_bf16 v[112:127], v[152:155], v[132:135], v[112:127]
    v_exp_f32 v69, v69
    v_exp_f32 v70, v70
    v_exp_f32 v71, v71
    v_exp_f32 v72, v72
    v_cvt_pk_bf16_f32 v128, v64, v65
    v_cvt_pk_bf16_f32 v129, v66, v67
    v_mfma_f32_32x32x8_bf16 v[80:95], v[146:147], v[18:19], v[80:95]
    v_cvt_pk_bf16_f32 v130, v68, v69
    v_cvt_pk_bf16_f32 v131, v70, v71
    v_exp_f32 v73, v73
    v_exp_f32 v74, v74
    v_exp_f32 v75, v75
    v_exp_f32 v76, v76
    s_waitcnt lgkmcnt(2)
    v_mfma_f32_32x32x16_bf16 v[96:111], v[156:159], v[128:131], v[96:111]
    v_exp_f32 v77, v77
    v_exp_f32 v78, v78
    v_exp_f32 v79, v79
    v_cvt_pk_bf16_f32 v132, v72, v73
    v_cvt_pk_bf16_f32 v133, v74, v75
    v_cvt_pk_bf16_f32 v134, v76, v77
    v_cvt_pk_bf16_f32 v135, v78, v79
    s_waitcnt lgkmcnt(0)
    v_mfma_f32_32x32x16_bf16 v[64:79], v[136:139], v[8:11], v[32:47]
    s_mov_b64 exec, s[34:35]
    ds_read_b128 v[148:151], v166 offset:7680
    ds_read_b128 v[152:155], v166 offset:8320
    s_mov_b64 exec, -1
    v_exp_f32 v80, v80
    v_exp_f32 v81, v81
    v_exp_f32 v82, v82
    v_exp_f32 v83, v83
    v_exp_f32 v84, v84
    v_mfma_f32_32x32x16_bf16 v[96:111], v[160:163], v[132:135], v[96:111]
    v_exp_f32 v85, v85
    v_exp_f32 v86, v86
    v_exp_f32 v87, v87
    v_exp_f32 v88, v88
    v_cvt_pk_bf16_f32 v128, v80, v81
    v_cvt_pk_bf16_f32 v129, v82, v83
    v_mfma_f32_32x32x8_bf16 v[64:79], v[144:145], v[16:17], v[64:79]
    v_cvt_pk_bf16_f32 v130, v84, v85
    v_cvt_pk_bf16_f32 v131, v86, v87
    v_exp_f32 v89, v89
    v_exp_f32 v90, v90
    v_exp_f32 v91, v91
    v_exp_f32 v92, v92
    v_mfma_f32_32x32x16_bf16 v[112:127], v[156:159], v[128:131], v[112:127]
    v_exp_f32 v93, v93
    v_exp_f32 v94, v94
    v_exp_f32 v95, v95
    v_cvt_pk_bf16_f32 v132, v88, v89
    v_cvt_pk_bf16_f32 v133, v90, v91
    v_cvt_pk_bf16_f32 v134, v92, v93
    v_cvt_pk_bf16_f32 v135, v94, v95
    v_mfma_f32_32x32x16_bf16 v[80:95], v[136:139], v[12:15], v[48:63]
    ds_read2st64_b64 v[140:143], v164 offset0:14 offset1:15
    ds_read_b64 v[146:147], v165 offset:1792
    v_exp_f32 v64, v64
    v_exp_f32 v65, v65
    v_exp_f32 v66, v66
    v_exp_f32 v67, v67
    v_exp_f32 v68, v68
    v_mfma_f32_32x32x16_bf16 v[112:127], v[160:163], v[132:135], v[112:127]
    v_exp_f32 v69, v69
    v_exp_f32 v70, v70
    v_exp_f32 v71, v71
    v_exp_f32 v72, v72
    v_cvt_pk_bf16_f32 v128, v64, v65
    v_cvt_pk_bf16_f32 v129, v66, v67
    v_mfma_f32_32x32x8_bf16 v[80:95], v[144:145], v[18:19], v[80:95]
    v_cvt_pk_bf16_f32 v130, v68, v69
    v_cvt_pk_bf16_f32 v131, v70, v71
    v_exp_f32 v73, v73
    v_exp_f32 v74, v74
    v_exp_f32 v75, v75
    v_exp_f32 v76, v76
    s_waitcnt lgkmcnt(2)
    v_mfma_f32_32x32x16_bf16 v[96:111], v[148:151], v[128:131], v[96:111]
    v_exp_f32 v77, v77
    v_exp_f32 v78, v78
    v_exp_f32 v79, v79
    v_cvt_pk_bf16_f32 v132, v72, v73
    v_cvt_pk_bf16_f32 v133, v74, v75
    v_cvt_pk_bf16_f32 v134, v76, v77
    v_cvt_pk_bf16_f32 v135, v78, v79
    s_waitcnt lgkmcnt(0)
    v_mfma_f32_32x32x16_bf16 v[64:79], v[140:143], v[8:11], v[32:47]
    s_mov_b64 exec, s[34:35]
    ds_read_b128 v[156:159], v166 offset:8960
    ds_read_b128 v[160:163], v166 offset:9600
    s_mov_b64 exec, -1
    v_exp_f32 v80, v80
    v_exp_f32 v81, v81
    v_exp_f32 v82, v82
    v_exp_f32 v83, v83
    v_exp_f32 v84, v84
    v_mfma_f32_32x32x16_bf16 v[96:111], v[152:155], v[132:135], v[96:111]
    v_exp_f32 v85, v85
    v_exp_f32 v86, v86
    v_exp_f32 v87, v87
    v_exp_f32 v88, v88
    v_cvt_pk_bf16_f32 v128, v80, v81
    v_cvt_pk_bf16_f32 v129, v82, v83
    v_mfma_f32_32x32x8_bf16 v[64:79], v[146:147], v[16:17], v[64:79]
    v_cvt_pk_bf16_f32 v130, v84, v85
    v_cvt_pk_bf16_f32 v131, v86, v87
    v_exp_f32 v89, v89
    v_exp_f32 v90, v90
    v_exp_f32 v91, v91
    v_exp_f32 v92, v92
    v_mfma_f32_32x32x16_bf16 v[112:127], v[148:151], v[128:131], v[112:127]
    v_exp_f32 v93, v93
    v_exp_f32 v94, v94
    v_exp_f32 v95, v95
    v_cvt_pk_bf16_f32 v132, v88, v89
    v_cvt_pk_bf16_f32 v133, v90, v91
    v_cvt_pk_bf16_f32 v134, v92, v93
    v_cvt_pk_bf16_f32 v135, v94, v95
    s_cmp_lg_u32 s38, s40
    s_cbranch_scc1 att_nb0
    s_barrier
    s_cmp_eq_u32 s40, 0
    s_cselect_b32 s40, 20480, -1
att_nb0:
    v_mfma_f32_32x32x16_bf16 v[80:95], v[140:143], v[12:15], v[48:63]
    ds_read2st64_b64 v[136:139], v167 offset0:0 offset1:1
    ds_read_b64 v[144:145], v168 offset:0
    v_exp_f32 v64, v64
    v_exp_f32 v65, v65
    v_exp_f32 v66, v66
    v_exp_f32 v67, v67
    v_exp_f32 v68, v68
    v_mfma_f32_32x32x16_bf16 v[112:127], v[152:155], v[132:135], v[112:127]
    v_exp_f32 v69, v69
    v_exp_f32 v70, v70
    v_exp_f32 v71, v71
    v_exp_f32 v72, v72
    v_cvt_pk_bf16_f32 v128, v64, v65
    v_cvt_pk_bf16_f32 v129, v66, v67
    v_mfma_f32_32x32x8_bf16 v[80:95], v[146:147], v[18:19], v[80:95]
    v_cvt_pk_bf16_f32 v130, v68, v69
    v_cvt_pk_bf16_f32 v131, v70, v71
    v_exp_f32 v73, v73
    v_exp_f32 v74, v74
    v_exp_f32 v75, v75
    v_exp_f32 v76, v76
    s_waitcnt lgkmcnt(2)
    v_mfma_f32_32x32x16_bf16 v[96:111], v[156:159], v[128:131], v[96:111]
    v_exp_f32 v77, v77
    v_exp_f32 v78, v78
    v_exp_f32 v79, v79
    v_cvt_pk_bf16_f32 v132, v72, v73
    v_cvt_pk_bf16_f32 v133, v74, v75
    v_cvt_pk_bf16_f32 v134, v76, v77
    v_cvt_pk_bf16_f32 v135, v78, v79
    s_waitcnt lgkmcnt(0)
    v_mfma_f32_32x32x16_bf16 v[64:79], v[136:139], v[8:11], v[32:47]
    s_mov_b64 exec, s[34:35]
    ds_read_b128 v[148:151], v169 offset:0
    ds_read_b128 v[152:155], v169 offset:640
    s_mov_b64 exec, -1
    v_exp_f32 v80, v80
    v_exp_f32 v81, v81
    v_exp_f32 v82, v82
    v_exp_f32 v83, v83
    v_exp_f32 v84, v84
    v_mfma_f32_32x32x16_bf16 v[96:111], v[160:163], v[132:135], v[96:111]
    v_exp_f32 v85, v85
    v_exp_f32 v86, v86
    v_exp_f32 v87, v87
    v_exp_f32 v88, v88
    v_cvt_pk_bf16_f32 v128, v80, v81
    v_cvt_pk_bf16_f32 v129, v82, v83
    v_mfma_f32_32x32x8_bf16 v[64:79], v[144:145], v[16:17], v[64:79]
    v_cvt_pk_bf16_f32 v130, v84, v85
    v_cvt_pk_bf16_f32 v131, v86, v87
    v_exp_f32 v89, v89
    v_exp_f32 v90, v90
    v_exp_f32 v91, v91
    v_exp_f32 v92, v92
    v_mfma_f32_32x32x16_bf16 v[112:127], v[156:159], v[128:131], v[112:127]
    v_exp_f32 v93, v93
    v_exp_f32 v94, v94
    v_exp_f32 v95, v95
    v_cvt_pk_bf16_f32 v132, v88, v89
    v_cvt_pk_bf16_f32 v133, v90, v91
    v_cvt_pk_bf16_f32 v134, v92, v93
    v_cvt_pk_bf16_f32 v135, v94, v95
    s_mov_b32 s38, s39
    s_cmp_lg_u32 s38, 0
    s_cbranch_scc1 att_loop
    v_mfma_f32_32x32x16_bf16 v[112:127], v[160:163], v[132:135], v[112:127]
    s_waitcnt lgkmcnt(0)
    v_mov_b32 v6, v104
    v_mov_b32 v28, v104
    s_nop 8
    v_mov_b32 v7, v120
    v_mov_b32 v29, v120
    v_permlane32_swap_b32 v6, v28
    s_nop 0
    v_permlane32_swap_b32 v7, v29
    s_cmp_lg_u32 s37, 0
    s_cbranch_scc1 att_out
    v_mov_b32 v6, 0x4b800000
    v_cmp_nle_f32 vcc, v28, v6
    v_cmp_nle_f32 s[44:45], v29, v6
    s_nop 1
    s_or_b64 vcc, vcc, s[44:45]
    s_cmp_eq_u64 vcc, 0
    s_cbranch_scc1 att_out
    s_mov_b32 s37, 1
    s_mov_b32 s38, 0
    v_mov_b32 v6, 0xff800000
    v_mov_b32 v7, 0xff800000
att_maxloop:
    v_add_u32 v164, s38, v170
    v_add_u32 v165, s38, v171
    s_mov_b32 s39, 0
att_maxl2:
    ds_read2st64_b64 v[136:139], v164 offset1:1
    ds_read_b64 v[144:145], v165
    v_add_u32 v164, 1024, v164
    v_add_u32 v165, 256, v165
    s_waitcnt lgkmcnt(0)
    v_mfma_f32_32x32x16_bf16 v[64:79], v[136:139], v[8:11], 0
    v_mfma_f32_32x32x16_bf16 v[80:95], v[136:139], v[12:15], 0
    v_mfma_f32_32x32x8_bf16 v[64:79], v[144:145], v[16:17], v[64:79]
    v_mfma_f32_32x32x8_bf16 v[80:95], v[144:145], v[18:19], v[80:95]
    s_nop 10
    v_max3_f32 v6, v6, v64, v65
    v_max3_f32 v6, v6, v66, v67
    v_max3_f32 v6, v6, v68, v69
    v_max3_f32 v6, v6, v70, v71
    v_max3_f32 v6, v6, v72, v73
    v_max3_f32 v6, v6, v74, v75
    v_max3_f32 v6, v6, v76, v77
    v_max3_f32 v6, v6, v78, v79
    v_max3_f32 v7, v7, v80, v81
    v_max3_f32 v7, v7, v82, v83
    v_max3_f32 v7, v7, v84, v85
    v_max3_f32 v7, v7, v86, v87
    v_max3_f32 v7, v7, v88, v89
    v_max3_f32 v7, v7, v90, v91
    v_max3_f32 v7, v7, v92, v93
    v_max3_f32 v7, v7, v94, v95
    s_add_u32 s39, s39, 1
    s_cmp_lt_u32 s39, 8
    s_cbranch_scc1 att_maxl2
    s_add_u32 s38, s38, 20480
    s_cmp_lg_u32 s38, 163840
    s_cbranch_scc1 att_maxloop
    s_branch att_setmax
att_out:
    s_barrier
    v_rcp_f32 v28, v28
    v_rcp_f32 v29, v29
    s_and_b32 s29, s24, 1
    v_mul_f32 v96, v28, v96
    v_mul_f32 v97, v28, v97
    v_mul_f32 v98, v28, v98
    v_mul_f32 v99, v28, v99
    v_cvt_pk_bf16_f32 v32, v96, v97
    v_cvt_pk_bf16_f32 v33, v98, v99
    v_mul_f32 v112, v29, v112
    v_mul_f32 v113, v29, v113
    v_mul_f32 v114, v29, v114
    v_mul_f32 v115, v29, v115
    v_cvt_pk_bf16_f32 v34, v112, v113
    v_cvt_pk_bf16_f32 v35, v114, v115
    s_nop 0
    v_permlane32_swap_b32 v32, v34
    v_permlane32_swap_b32 v33, v35
    v_mul_f32 v100, v28, v100
    v_mul_f32 v101, v28, v101
    v_mul_f32 v102, v28, v102
    v_mul_f32 v103, v28, v103
    v_cvt_pk_bf16_f32 v36, v100, v101
    v_cvt_pk_bf16_f32 v37, v102, v103
    v_mul_f32 v116, v29, v116
    v_mul_f32 v117, v29, v117
    v_mul_f32 v118, v29, v118
    v_mul_f32 v119, v29, v119
    v_cvt_pk_bf16_f32 v38, v116, v117
    v_cvt_pk_bf16_f32 v39, v118, v119
    s_nop 0
    v_permlane32_swap_b32 v36, v38
    v_permlane32_swap_b32 v37, v39
    v_mul_f32 v104, v28, v104
    v_mul_f32 v105, v28, v105
    v_mul_f32 v106, v28, v106
    v_mul_f32 v107, v28, v107
    v_cvt_pk_bf16_f32 v40, v104, v105
    v_cvt_pk_bf16_f32 v41, v106, v107
    v_mul_f32 v120, v29, v120
    v_mul_f32 v121, v29, v121
    v_mul_f32 v122, v29, v122
    v_mul_f32 v123, v29, v123
    v_cvt_pk_bf16_f32 v42, v120, v121
    v_cvt_pk_bf16_f32 v43, v122, v123
    s_nop 0
    v_permlane32_swap_b32 v40, v42
    v_permlane32_swap_b32 v41, v43
    s_cmp_lg_u32 s29, 0
    s_cbranch_scc1 att_odd
    buffer_store_dwordx4 v[32:35], v20, s[12:15], s61 offen sc1
    buffer_store_dwordx4 v[36:39], v20, s[12:15], s62 offen sc1
    buffer_store_dwordx2 v[40:41], v20, s[12:15], s63 offen sc1
    s_branch att_st
att_odd:
    buffer_store_dwordx2 v[32:33], v20, s[12:15], s61 offen offset:8 sc1
    buffer_store_dwordx4 v[34:37], v20, s[12:15], s62 offen sc1
    buffer_store_dwordx4 v[38:41], v20, s[12:15], s63 offen sc1
att_st:
    s_mov_b64 exec, -1
    s_lshl_b32 s31, s60, 17
    s_add_u32 s31, s31, 18546688
    s_lshl_b32 s49, s25, 12
    s_add_u32 s31, s31, s49
    s_and_b32 s51, s2, 3
    s_lshl_b32 s51, s51, 10
    s_add_u32 s51, s51, s31
    s_and_b32 s32, s2, 31
    s_lshl_b32 s32, s32, 5
    s_add_u32 s49, s32, s31
    v_lshlrev_b32 v9, 10, v2
    v_lshlrev_b32 v10, 5, v2
    s_mov_b32 s14, 18833408
    s_waitcnt vmcnt(0)
    s_barrier
    s_cmp_lg_u32 s26, 0
    s_cbranch_scc1 att_nosig
    v_mov_b32 v4, 1
    s_mov_b64 exec, 0xf
    buffer_store_dword v4, v9, s[12:15], s49 offen sc0 sc1
    s_mov_b64 exec, -1
att_nosig:
    v_mov_b32 v240, v10
    s_mov_b32 s90, s51
    s_branch wo_compute
wo_loader:
    s_lshr_b32 s24, s2, 5
    s_lshl_b32 s24, s24, 2
    s_and_b32 s25, s2, 7
    s_lshr_b32 s27, s25, 1
    s_add_u32 s24, s24, s27
    s_and_b32 s25, s25, 1
    s_lshl_b32 s25, s25, 2
    s_bfe_u32 s27, s2, 0x20003
    s_add_u32 s25, s25, s27
    v_lshlrev_b32 v3, 4, v2
    s_mov_b32 s12, s8
    s_mov_b32 s13, s9
    s_mov_b32 s14, 18833408
    s_mov_b32 s15, 0x20000
    s_sub_u32 s27, s26, 4
    s_mul_i32 s33, s24, 81920
    s_mul_i32 s34, s27, 5120
    s_add_u32 s33, s33, s34
    s_add_u32 s33, s33, 7864320
    s_mul_i32 s34, s25, 102400
    s_mul_i32 s35, s27, 25600
    s_add_u32 s34, s34, s35
    s_add_u32 s34, s34, 17727488
    s_mul_i32 s50, s27, 9216
    s_lshl_b32 s49, s60, 13
    s_lshr_b32 s31, s2, 5
    s_lshl_b32 s31, s31, 7
    s_add_u32 s49, s49, s31
    s_add_u32 s49, s49, 18546688
    v_mov_b32 v10, 0
    s_barrier
    s_barrier
    s_add_u32 m0, s50, 4096
    s_add_u32 s35, s34, 0
    buffer_load_dwordx4 v3, s[12:15], s35 offen lds
    s_add_u32 m0, s50, 5120
    s_add_u32 s35, s34, 1024
    buffer_load_dwordx4 v3, s[12:15], s35 offen lds
    s_add_u32 m0, s50, 6144
    s_add_u32 s35, s34, 2048
    buffer_load_dwordx4 v3, s[12:15], s35 offen lds
    s_add_u32 m0, s50, 7168
    s_add_u32 s35, s34, 3072
    buffer_load_dwordx4 v3, s[12:15], s35 offen lds
    s_add_u32 m0, s50, 8192
    s_add_u32 s35, s34, 4096
    buffer_load_dwordx4 v3, s[12:15], s35 offen lds
    s_add_u32 m0, s50, 40960
    s_add_u32 s35, s34, 5120
    buffer_load_dwordx4 v3, s[12:15], s35 offen lds
    s_add_u32 m0, s50, 41984
    s_add_u32 s35, s34, 6144
    buffer_load_dwordx4 v3, s[12:15], s35 offen lds
    s_add_u32 m0, s50, 43008
    s_add_u32 s35, s34, 7168
    buffer_load_dwordx4 v3, s[12:15], s35 offen lds
    s_add_u32 m0, s50, 44032
    s_add_u32 s35, s34, 8192
    buffer_load_dwordx4 v3, s[12:15], s35 offen lds
    s_add_u32 m0, s50, 45056
    s_add_u32 s35, s34, 9216
    buffer_load_dwordx4 v3, s[12:15], s35 offen lds
    s_add_u32 m0, s50, 77824
    s_add_u32 s35, s34, 10240
    buffer_load_dwordx4 v3, s[12:15], s35 offen lds
    s_add_u32 m0, s50, 78848
    s_add_u32 s35, s34, 11264
    buffer_load_dwordx4 v3, s[12:15], s35 offen lds
    s_add_u32 m0, s50, 79872
    s_add_u32 s35, s34, 12288
    buffer_load_dwordx4 v3, s[12:15], s35 offen lds
    s_add_u32 m0, s50, 80896
    s_add_u32 s35, s34, 13312
    buffer_load_dwordx4 v3, s[12:15], s35 offen lds
    s_add_u32 m0, s50, 81920
    s_add_u32 s35, s34, 14336
    buffer_load_dwordx4 v3, s[12:15], s35 offen lds
    s_add_u32 m0, s50, 114688
    s_add_u32 s35, s34, 15360
    buffer_load_dwordx4 v3, s[12:15], s35 offen lds
    s_add_u32 m0, s50, 115712
    s_add_u32 s35, s34, 16384
    buffer_load_dwordx4 v3, s[12:15], s35 offen lds
    s_add_u32 m0, s50, 116736
    s_add_u32 s35, s34, 17408
    buffer_load_dwordx4 v3, s[12:15], s35 offen lds
    s_add_u32 m0, s50, 117760
    s_add_u32 s35, s34, 18432
    buffer_load_dwordx4 v3, s[12:15], s35 offen lds
    s_add_u32 m0, s50, 118784
    s_add_u32 s35, s34, 19456
    buffer_load_dwordx4 v3, s[12:15], s35 offen lds
    s_barrier
    s_add_u32 m0, s50, 0
    s_add_u32 s35, s33, 0
    buffer_load_dwordx4 v3, s[12:15], s35 offen sc1 lds
    s_add_u32 m0, s50, 1024
    s_add_u32 s35, s33, 20480
    buffer_load_dwordx4 v3, s[12:15], s35 offen sc1 lds
    s_add_u32 m0, s50, 2048
    s_add_u32 s35, s33, 40960
    buffer_load_dwordx4 v3, s[12:15], s35 offen sc1 lds
    s_add_u32 m0, s50, 3072
    s_add_u32 s35, s33, 61440
    buffer_load_dwordx4 v3, s[12:15], s35 offen sc1 lds
    s_add_u32 m0, s50, 36864
    s_add_u32 s35, s33, 1024
    buffer_load_dwordx4 v3, s[12:15], s35 offen sc1 lds
    s_add_u32 m0, s50, 37888
    s_add_u32 s35, s33, 21504
    buffer_load_dwordx4 v3, s[12:15], s35 offen sc1 lds
    s_add_u32 m0, s50, 38912
    s_add_u32 s35, s33, 41984
    buffer_load_dwordx4 v3, s[12:15], s35 offen sc1 lds
    s_add_u32 m0, s50, 39936
    s_add_u32 s35, s33, 62464
    buffer_load_dwordx4 v3, s[12:15], s35 offen sc1 lds
    s_waitcnt vmcnt(4)
    s_barrier
    s_add_u32 m0, s50, 73728
    s_add_u32 s35, s33, 2048
    buffer_load_dwordx4 v3, s[12:15], s35 offen sc1 lds
    s_add_u32 m0, s50, 74752
    s_add_u32 s35, s33, 22528
    buffer_load_dwordx4 v3, s[12:15], s35 offen sc1 lds
    s_add_u32 m0, s50, 75776
    s_add_u32 s35, s33, 43008
    buffer_load_dwordx4 v3, s[12:15], s35 offen sc1 lds
    s_add_u32 m0, s50, 76800
    s_add_u32 s35, s33, 63488
    buffer_load_dwordx4 v3, s[12:15], s35 offen sc1 lds
    s_add_u32 m0, s50, 110592
    s_add_u32 s35, s33, 3072
    buffer_load_dwordx4 v3, s[12:15], s35 offen sc1 lds
    s_add_u32 m0, s50, 111616
    s_add_u32 s35, s33, 23552
    buffer_load_dwordx4 v3, s[12:15], s35 offen sc1 lds
    s_add_u32 m0, s50, 112640
    s_add_u32 s35, s33, 44032
    buffer_load_dwordx4 v3, s[12:15], s35 offen sc1 lds
    s_add_u32 m0, s50, 113664
    s_add_u32 s35, s33, 64512
    buffer_load_dwordx4 v3, s[12:15], s35 offen sc1 lds
    s_waitcnt vmcnt(8)
    s_barrier
    s_add_u32 m0, s50, 0
    s_add_u32 s35, s33, 4096
    buffer_load_dwordx4 v3, s[12:15], s35 offen sc1 lds
    s_add_u32 m0, s50, 1024
    s_add_u32 s35, s33, 24576
    buffer_load_dwordx4 v3, s[12:15], s35 offen sc1 lds
    s_add_u32 m0, s50, 2048
    s_add_u32 s35, s33, 45056
    buffer_load_dwordx4 v3, s[12:15], s35 offen sc1 lds
    s_add_u32 m0, s50, 3072
    s_add_u32 s35, s33, 65536
    buffer_load_dwordx4 v3, s[12:15], s35 offen sc1 lds
    s_add_u32 m0, s50, 4096
    s_add_u32 s35, s34, 20480
    buffer_load_dwordx4 v3, s[12:15], s35 offen lds
    s_add_u32 m0, s50, 5120
    s_add_u32 s35, s34, 21504
    buffer_load_dwordx4 v3, s[12:15], s35 offen lds
    s_add_u32 m0, s50, 6144
    s_add_u32 s35, s34, 22528
    buffer_load_dwordx4 v3, s[12:15], s35 offen lds
    s_add_u32 m0, s50, 7168
    s_add_u32 s35, s34, 23552
    buffer_load_dwordx4 v3, s[12:15], s35 offen lds
    s_add_u32 m0, s50, 8192
    s_add_u32 s35, s34, 24576
    buffer_load_dwordx4 v3, s[12:15], s35 offen lds
    s_waitcnt vmcnt(13)
    s_barrier
    s_waitcnt vmcnt(9)
    s_barrier
    s_waitcnt vmcnt(0)
    s_barrier
    s_waitcnt vmcnt(0)
    s_barrier
    s_barrier
    s_barrier
    s_branch m1_loader
wo_compute:
    s_load_dwordx2 s[4:5], s[0:1], 0
    s_lshl_b32 s40, s60, 14
    s_add_u32 s40, s40, 17694720
    s_cmp_eq_u32 s60, 0
    s_movk_i32 s41, 128
    s_cselect_b32 s41, 1280, s41
    s_mov_b32 s42, 262144
    s_cselect_b32 s42, 128, s42
    s_movk_i32 s43, 128
    s_mov_b32 s48, 262144
    s_waitcnt lgkmcnt(0)
    s_cbranch_scc1 wo_c1
    s_add_u32 s4, s8, 13107200
    s_addc_u32 s5, s9, 0
wo_c1:
    s_lshr_b32 s24, s2, 5
    s_lshl_b32 s24, s24, 2
    s_and_b32 s25, s2, 7
    s_lshr_b32 s27, s25, 1
    s_add_u32 s24, s24, s27
    s_and_b32 s25, s25, 1
    s_lshl_b32 s25, s25, 2
    s_bfe_u32 s27, s2, 0x20003
    s_add_u32 s25, s25, s27
    v_lshlrev_b32 v3, 4, v2
    s_mov_b32 s20, s4
    s_mov_b32 s21, s5
    s_mov_b32 s22, 2621440
    s_mov_b32 s23, 0x20000
    s_add_u32 s44, s8, 10485760
    s_addc_u32 s45, s9, 0
    s_mov_b32 s46, 2621440
    s_mov_b32 s47, 0x20000
    s_lshr_b32 s27, s26, 1
    s_and_b32 s28, s26, 1
    s_lshl_b32 s29, s28, 1
    s_add_u32 s29, s29, s27
    v_and_b32 v4, 15, v2
    v_lshrrev_b32 v5, 4, v2
    s_mul_i32 s32, s25, 80
    s_lshl_b32 s31, s24, 2
    s_add_u32 s31, s31, s29
    s_lshl_b32 s31, s31, 4
    s_mul_i32 s30, s31, s41
    s_mul_i32 s31, s31, s43
    v_mul_u32_u24 v6, s41, v4
    v_mul_u32_u24 v7, s43, v4
    v_lshl_add_u32 v8, v5, 3, s32
    v_add_u32 v8, 0, v8
    v_lshrrev_b32 v9, 6, v8
    v_and_b32 v8, 63, v8
    v_lshl_add_u32 v10, v8, 1, v6
    v_mad_u32_u24 v14, v9, s42, v10
    buffer_load_dwordx4 v[20:23], v14, s[20:23], s30 offen sc1
    v_lshl_add_u32 v10, v8, 1, v7
    v_mad_u32_u24 v17, v9, s48, v10
    v_lshl_add_u32 v8, v5, 3, s32
    v_add_u32 v8, 32, v8
    v_lshrrev_b32 v9, 6, v8
    v_and_b32 v8, 63, v8
    v_lshl_add_u32 v10, v8, 1, v6
    v_mad_u32_u24 v15, v9, s42, v10
    buffer_load_dwordx4 v[24:27], v15, s[20:23], s30 offen sc1
    v_lshl_add_u32 v10, v8, 1, v7
    v_mad_u32_u24 v18, v9, s48, v10
    v_lshl_add_u32 v8, v5, 2, s32
    v_add_u32 v8, 64, v8
    v_lshrrev_b32 v9, 6, v8
    v_and_b32 v8, 63, v8
    v_lshl_add_u32 v10, v8, 1, v6
    v_mad_u32_u24 v16, v9, s42, v10
    buffer_load_dwordx2 v[28:29], v16, s[20:23], s30 offen sc1
    v_lshl_add_u32 v10, v8, 1, v7
    v_mad_u32_u24 v19, v9, s48, v10
    s_mul_i32 s30, s27, 18432
    v_add_u32 v10, s30, v3
    s_lshl_b32 s32, s29, 10
    v_add_u32 v8, s32, v10
    s_xor_b32 s32, s32, 1024
    v_add_u32 v9, s32, v10
    v_mov_b32 v11, v8
    v_mov_b32 v12, v9
    v_mov_b32 v13, v10
    v_mov_b32 v64, 0
    v_mov_b32 v65, 0
    v_mov_b32 v66, 0
    v_mov_b32 v67, 0
    v_mov_b32 v68, 0
    v_mov_b32 v69, 0
    v_mov_b32 v70, 0
    v_mov_b32 v71, 0
    v_mov_b32 v72, 0
    v_mov_b32 v73, 0
    v_mov_b32 v74, 0
    v_mov_b32 v75, 0
    v_mov_b32 v76, 0
    v_mov_b32 v77, 0
    v_mov_b32 v78, 0
    v_mov_b32 v79, 0
    v_mov_b32 v80, 0
    v_mov_b32 v81, 0
    v_mov_b32 v82, 0
    v_mov_b32 v83, 0
    v_mov_b32 v84, 0
    v_mov_b32 v85, 0
    v_mov_b32 v86, 0
    v_mov_b32 v87, 0
    v_mov_b32 v88, 0
    v_mov_b32 v89, 0
    v_mov_b32 v90, 0
    v_mov_b32 v91, 0
    v_mov_b32 v92, 0
    v_mov_b32 v93, 0
    v_mov_b32 v94, 0
    v_mov_b32 v95, 0
    v_mov_b32 v96, 0
    v_mov_b32 v97, 0
    v_mov_b32 v98, 0
    v_mov_b32 v99, 0
    v_mov_b32 v100, 0
    v_mov_b32 v101, 0
    v_mov_b32 v102, 0
    v_mov_b32 v103, 0
    s_cmp_lg_u32 s26, 1
    s_cbranch_scc1 awx_np
    s_mov_b32 s92, 65536
    s_mov_b32 exec_hi, 0
awx_pl:
    buffer_load_dword v244, v240, s[12:15], s90 offen sc1
    s_waitcnt vmcnt(0)
    v_cmp_eq_u32 vcc, 0, v244
    s_nop 1
    s_cmp_eq_u64 vcc, 0
    s_cbranch_scc1 awx_px
    s_sub_u32 s92, s92, 1
    s_cmp_lg_u32 s92, 0
    s_cbranch_scc1 awx_pl
awx_px:
    s_mov_b64 exec, -1
awx_np:
    s_barrier
    s_mov_b32 s50, 0
    s_mov_b32 s53, 5
    s_barrier
    ds_read_b128 v[104:107], v11 offset:0
    ds_read_b128 v[108:111], v12 offset:0
    ds_read_b128 v[112:115], v13 offset:4096
    ds_read_b128 v[116:119], v13 offset:5120
    ds_read_b128 v[120:123], v13 offset:6144
    ds_read_b128 v[124:127], v13 offset:7168
    ds_read_b128 v[128:131], v13 offset:8192
    ds_read_b128 v[132:135], v11 offset:9216
    ds_read_b128 v[136:139], v12 offset:9216
    ds_read_b128 v[140:143], v13 offset:13312
    ds_read_b128 v[144:147], v13 offset:14336
    ds_read_b128 v[148:151], v13 offset:15360
    ds_read_b128 v[152:155], v13 offset:16384
    ds_read_b128 v[156:159], v13 offset:17408
wo_cl:
    s_add_u32 s50, s50, 36864
    s_cmp_eq_u32 s50, 147456
    s_cselect_b32 s50, 0, s50
    v_add_u32 v11, s50, v8
    v_add_u32 v12, s50, v9
    v_add_u32 v13, s50, v10
    s_waitcnt lgkmcnt(0)
    s_barrier
    v_mfma_f32_16x16x32_bf16 v[64:67], v[112:115], v[104:107], v[64:67]
    ds_read_b128 v[160:163], v11 offset:0
    v_mfma_f32_16x16x32_bf16 v[68:71], v[112:115], v[108:111], v[68:71]
    ds_read_b128 v[164:167], v12 offset:0
    v_mfma_f32_16x16x32_bf16 v[72:75], v[116:119], v[104:107], v[72:75]
    ds_read_b128 v[168:171], v13 offset:4096
    v_mfma_f32_16x16x32_bf16 v[76:79], v[116:119], v[108:111], v[76:79]
    ds_read_b128 v[172:175], v13 offset:5120
    v_mfma_f32_16x16x32_bf16 v[80:83], v[120:123], v[104:107], v[80:83]
    ds_read_b128 v[176:179], v13 offset:6144
    v_mfma_f32_16x16x32_bf16 v[84:87], v[120:123], v[108:111], v[84:87]
    ds_read_b128 v[180:183], v13 offset:7168
    v_mfma_f32_16x16x32_bf16 v[88:91], v[124:127], v[104:107], v[88:91]
    ds_read_b128 v[184:187], v13 offset:8192
    v_mfma_f32_16x16x32_bf16 v[92:95], v[124:127], v[108:111], v[92:95]
    ds_read_b128 v[188:191], v11 offset:9216
    v_mfma_f32_16x16x32_bf16 v[96:99], v[128:131], v[104:107], v[96:99]
    ds_read_b128 v[192:195], v12 offset:9216
    v_mfma_f32_16x16x32_bf16 v[100:103], v[128:131], v[108:111], v[100:103]
    ds_read_b128 v[196:199], v13 offset:13312
    v_mfma_f32_16x16x32_bf16 v[64:67], v[140:143], v[132:135], v[64:67]
    ds_read_b128 v[200:203], v13 offset:14336
    v_mfma_f32_16x16x32_bf16 v[68:71], v[140:143], v[136:139], v[68:71]
    ds_read_b128 v[204:207], v13 offset:15360
    v_mfma_f32_16x16x32_bf16 v[72:75], v[144:147], v[132:135], v[72:75]
    ds_read_b128 v[208:211], v13 offset:16384
    v_mfma_f32_16x16x32_bf16 v[76:79], v[144:147], v[136:139], v[76:79]
    ds_read_b128 v[212:215], v13 offset:17408
    v_mfma_f32_16x16x32_bf16 v[80:83], v[148:151], v[132:135], v[80:83]
    v_mfma_f32_16x16x32_bf16 v[84:87], v[148:151], v[136:139], v[84:87]
    v_mfma_f32_16x16x32_bf16 v[88:91], v[152:155], v[132:135], v[88:91]
    v_mfma_f32_16x16x32_bf16 v[92:95], v[152:155], v[136:139], v[92:95]
    v_mfma_f32_16x16x32_bf16 v[96:99], v[156:159], v[132:135], v[96:99]
    v_mfma_f32_16x16x32_bf16 v[100:103], v[156:159], v[136:139], v[100:103]
    s_sub_u32 s53, s53, 1
    s_cmp_eq_u32 s53, 0
    s_cbranch_scc1 wo_cx
    s_add_u32 s50, s50, 36864
    s_cmp_eq_u32 s50, 147456
    s_cselect_b32 s50, 0, s50
    v_add_u32 v11, s50, v8
    v_add_u32 v12, s50, v9
    v_add_u32 v13, s50, v10
    s_waitcnt lgkmcnt(0)
    s_barrier
    v_mfma_f32_16x16x32_bf16 v[64:67], v[168:171], v[160:163], v[64:67]
    ds_read_b128 v[104:107], v11 offset:0
    v_mfma_f32_16x16x32_bf16 v[68:71], v[168:171], v[164:167], v[68:71]
    ds_read_b128 v[108:111], v12 offset:0
    v_mfma_f32_16x16x32_bf16 v[72:75], v[172:175], v[160:163], v[72:75]
    ds_read_b128 v[112:115], v13 offset:4096
    v_mfma_f32_16x16x32_bf16 v[76:79], v[172:175], v[164:167], v[76:79]
    ds_read_b128 v[116:119], v13 offset:5120
    v_mfma_f32_16x16x32_bf16 v[80:83], v[176:179], v[160:163], v[80:83]
    ds_read_b128 v[120:123], v13 offset:6144
    v_mfma_f32_16x16x32_bf16 v[84:87], v[176:179], v[164:167], v[84:87]
    ds_read_b128 v[124:127], v13 offset:7168
    v_mfma_f32_16x16x32_bf16 v[88:91], v[180:183], v[160:163], v[88:91]
    ds_read_b128 v[128:131], v13 offset:8192
    v_mfma_f32_16x16x32_bf16 v[92:95], v[180:183], v[164:167], v[92:95]
    ds_read_b128 v[132:135], v11 offset:9216
    v_mfma_f32_16x16x32_bf16 v[96:99], v[184:187], v[160:163], v[96:99]
    ds_read_b128 v[136:139], v12 offset:9216
    v_mfma_f32_16x16x32_bf16 v[100:103], v[184:187], v[164:167], v[100:103]
    ds_read_b128 v[140:143], v13 offset:13312
    v_mfma_f32_16x16x32_bf16 v[64:67], v[196:199], v[188:191], v[64:67]
    ds_read_b128 v[144:147], v13 offset:14336
    v_mfma_f32_16x16x32_bf16 v[68:71], v[196:199], v[192:195], v[68:71]
    ds_read_b128 v[148:151], v13 offset:15360
    v_mfma_f32_16x16x32_bf16 v[72:75], v[200:203], v[188:191], v[72:75]
    ds_read_b128 v[152:155], v13 offset:16384
    v_mfma_f32_16x16x32_bf16 v[76:79], v[200:203], v[192:195], v[76:79]
    ds_read_b128 v[156:159], v13 offset:17408
    v_mfma_f32_16x16x32_bf16 v[80:83], v[204:207], v[188:191], v[80:83]
    v_mfma_f32_16x16x32_bf16 v[84:87], v[204:207], v[192:195], v[84:87]
    v_mfma_f32_16x16x32_bf16 v[88:91], v[208:211], v[188:191], v[88:91]
    v_mfma_f32_16x16x32_bf16 v[92:95], v[208:211], v[192:195], v[92:95]
    v_mfma_f32_16x16x32_bf16 v[96:99], v[212:215], v[188:191], v[96:99]
    v_mfma_f32_16x16x32_bf16 v[100:103], v[212:215], v[192:195], v[100:103]
    s_sub_u32 s53, s53, 1
    s_cmp_eq_u32 s53, 0
    s_cbranch_scc0 wo_cl
wo_cx:
    s_waitcnt lgkmcnt(0)
    s_mul_i32 s30, s26, 5120
    v_add_u32 v4, s30, v3
    s_xor_b32 s30, s26, 2
    s_mul_i32 s30, s30, 5120
    v_add_u32 v5, s30, v3
    ds_write_b128 v4, v[68:71] offset:0
    ds_write_b128 v4, v[76:79] offset:1024
    ds_write_b128 v4, v[84:87] offset:2048
    ds_write_b128 v4, v[92:95] offset:3072
    ds_write_b128 v4, v[100:103] offset:4096
    s_waitcnt vmcnt(0)
    v_lshlrev_b32 v32, 16, v20
    v_and_b32 v33, 0xffff0000, v20
    v_lshlrev_b32 v34, 16, v21
    v_and_b32 v35, 0xffff0000, v21
    v_lshlrev_b32 v36, 16, v22
    v_and_b32 v37, 0xffff0000, v22
    v_lshlrev_b32 v38, 16, v23
    v_and_b32 v39, 0xffff0000, v23
    v_lshlrev_b32 v40, 16, v24
    v_and_b32 v41, 0xffff0000, v24
    v_lshlrev_b32 v42, 16, v25
    v_and_b32 v43, 0xffff0000, v25
    v_lshlrev_b32 v44, 16, v26
    v_and_b32 v45, 0xffff0000, v26
    v_lshlrev_b32 v46, 16, v27
    v_and_b32 v47, 0xffff0000, v27
    v_lshlrev_b32 v48, 16, v28
    v_and_b32 v49, 0xffff0000, v28
    v_lshlrev_b32 v50, 16, v29
    v_and_b32 v51, 0xffff0000, v29
    s_waitcnt lgkmcnt(0)
    s_barrier
    ds_read_b128 v[68:71], v5 offset:0
    ds_read_b128 v[76:79], v5 offset:1024
    ds_read_b128 v[84:87], v5 offset:2048
    ds_read_b128 v[92:95], v5 offset:3072
    ds_read_b128 v[100:103], v5 offset:4096
    v_pk_add_f32 v[32:33], v[64:65], v[32:33]
    v_pk_add_f32 v[34:35], v[66:67], v[34:35]
    v_pk_add_f32 v[36:37], v[72:73], v[36:37]
    v_pk_add_f32 v[38:39], v[74:75], v[38:39]
    v_pk_add_f32 v[40:41], v[80:81], v[40:41]
    v_pk_add_f32 v[42:43], v[82:83], v[42:43]
    v_pk_add_f32 v[44:45], v[88:89], v[44:45]
    v_pk_add_f32 v[46:47], v[90:91], v[46:47]
    v_pk_add_f32 v[48:49], v[96:97], v[48:49]
    v_pk_add_f32 v[50:51], v[98:99], v[50:51]
    s_waitcnt lgkmcnt(3)
    v_pk_add_f32 v[32:33], v[68:69], v[32:33]
    v_pk_add_f32 v[34:35], v[70:71], v[34:35]
    v_pk_add_f32 v[36:37], v[76:77], v[36:37]
    v_pk_add_f32 v[38:39], v[78:79], v[38:39]
    v_cvt_pk_bf16_f32 v20, v32, v33
    v_cvt_pk_bf16_f32 v21, v34, v35
    v_cvt_pk_bf16_f32 v22, v36, v37
    v_cvt_pk_bf16_f32 v23, v38, v39
    buffer_store_dwordx4 v[20:23], v17, s[44:47], s31 offen sc1
    s_waitcnt lgkmcnt(1)
    v_pk_add_f32 v[40:41], v[84:85], v[40:41]
    v_pk_add_f32 v[42:43], v[86:87], v[42:43]
    v_pk_add_f32 v[44:45], v[92:93], v[44:45]
    v_pk_add_f32 v[46:47], v[94:95], v[46:47]
    v_cvt_pk_bf16_f32 v24, v40, v41
    v_cvt_pk_bf16_f32 v25, v42, v43
    v_cvt_pk_bf16_f32 v26, v44, v45
    v_cvt_pk_bf16_f32 v27, v46, v47
    buffer_store_dwordx4 v[24:27], v18, s[44:47], s31 offen sc1
    s_waitcnt lgkmcnt(0)
    v_pk_add_f32 v[48:49], v[100:101], v[48:49]
    v_pk_add_f32 v[50:51], v[102:103], v[50:51]
    v_cvt_pk_bf16_f32 v28, v48, v49
    v_cvt_pk_bf16_f32 v29, v50, v51
    buffer_store_dwordx2 v[28:29], v19, s[44:47], s31 offen sc1
    v_mov_b32 v8, 0
    v_mov_b32 v9, 0
    s_mov_b32 s36, 0x3f803f80
    v_dot2c_f32_bf16 v8, s36, v20
    v_dot2c_f32_bf16 v9, v20, v20
    v_dot2c_f32_bf16 v8, s36, v21
    v_dot2c_f32_bf16 v9, v21, v21
    v_dot2c_f32_bf16 v8, s36, v22
    v_dot2c_f32_bf16 v9, v22, v22
    v_dot2c_f32_bf16 v8, s36, v23
    v_dot2c_f32_bf16 v9, v23, v23
    v_dot2c_f32_bf16 v8, s36, v24
    v_dot2c_f32_bf16 v9, v24, v24
    v_dot2c_f32_bf16 v8, s36, v25
    v_dot2c_f32_bf16 v9, v25, v25
    v_dot2c_f32_bf16 v8, s36, v26
    v_dot2c_f32_bf16 v9, v26, v26
    v_dot2c_f32_bf16 v8, s36, v27
    v_dot2c_f32_bf16 v9, v27, v27
    v_dot2c_f32_bf16 v8, s36, v28
    v_dot2c_f32_bf16 v9, v28, v28
    v_dot2c_f32_bf16 v8, s36, v29
    v_dot2c_f32_bf16 v9, v29, v29
    s_nop 1
    v_mov_b32 v10, v8
    v_mov_b32 v11, v9
    s_nop 0
    v_permlane32_swap_b32 v8, v10
    v_permlane32_swap_b32 v9, v11
    v_add_f32 v8, v8, v10
    v_add_f32 v9, v9, v11
    v_mov_b32 v10, v8
    v_mov_b32 v11, v9
    s_nop 0
    v_permlane16_swap_b32 v8, v10
    v_permlane16_swap_b32 v9, v11
    v_add_f32 v8, v8, v10
    v_add_f32 v9, v9, v11
    v_cmp_gt_u32 vcc, 16, v2
    v_and_b32 v10, 15, v2
    v_lshlrev_b32 v10, 3, v10
    v_lshrrev_b32 v11, 4, v2
    v_lshl_add_u32 v10, v11, 2, v10
    v_cndmask_b32 v8, v9, v8, vcc
    s_lshl_b32 s32, s24, 9
    s_lshl_b32 s33, s29, 7
    s_add_u32 s32, s32, s33
    s_add_u32 s32, s32, s40
    s_mov_b32 exec_hi, 0
    buffer_atomic_add_f32 v8, v10, s[12:15], s32 offen sc1
    s_mov_b64 exec, -1
    s_lshl_b32 s31, s60, 17
    s_add_u32 s31, s31, 18579456
    s_lshl_b32 s49, s2, 4
    s_add_u32 s49, s49, s31
    s_and_b32 s51, s2, 7
    s_lshl_b32 s51, s51, 12
    s_add_u32 s51, s51, s31
    v_lshlrev_b32 v9, 12, v2
    v_lshlrev_b32 v10, 4, v2
    v_add_u32 v241, 1024, v10
    v_add_u32 v242, 2048, v10
    v_add_u32 v243, 3072, v10
    s_waitcnt vmcnt(0)
    s_barrier
    s_cmp_lg_u32 s26, 0
    s_cbranch_scc1 wox_nosig
    v_mov_b32 v4, 1
    s_mov_b64 exec, 0xff
    buffer_store_dword v4, v9, s[12:15], s49 offen sc0 sc1
    s_mov_b64 exec, -1
wox_nosig:
    v_mov_b32 v240, v10
    s_mov_b32 s90, s51
    s_branch m1_compute
m1_loader:
    s_cmp_ge_u32 s2, 240
    s_cbranch_scc1 m1_lskip
    s_load_dwordx2 s[10:11], s[0:1], 40
    s_and_b32 s27, s2, 7
    s_lshr_b32 s28, s2, 3
    s_mul_i32 s29, s28, 52429
    s_lshr_b32 s29, s29, 18
    s_mul_i32 s31, s29, 5
    s_sub_u32 s28, s28, s31
    s_and_b32 s31, s27, 1
    s_mul_i32 s31, s31, 5
    s_add_u32 s24, s31, s28
    s_lshr_b32 s31, s27, 1
    s_mul_i32 s31, s31, 6
    s_add_u32 s25, s31, s29
    s_add_u32 s55, s28, s29
    s_mul_i32 s55, s55, 0
    s_and_b32 s55, s55, 15
    s_lshl_b32 s38, s25, 7
    s_lshl_b32 s39, s26, 4
    s_add_u32 s38, s38, s39
    s_waitcnt lgkmcnt(0)
    s_add_u32 s10, s10, s38
    s_addc_u32 s11, s11, 0
    s_load_dwordx4 s[56:59], s[10:11], 0
    s_mov_b32 s12, s8
    s_mov_b32 s13, s9
    s_mov_b32 s14, 18833408
    s_mov_b32 s15, 0x20000
    s_sub_u32 s27, s26, 4
    s_add_u32 s16, s8, 18874368
    s_addc_u32 s17, s9, 0
    s_mov_b32 s18, 6291456
    s_mov_b32 s19, 0x20000
    s_add_u32 s20, s8, 10485760
    s_addc_u32 s21, s9, 0
    s_mov_b32 s22, 2621440
    s_mov_b32 s23, 0x20000
    v_lshrrev_b32 v4, 3, v2
    v_and_b32 v5, 7, v2
    v_lshrrev_b32 v6, 2, v2
    v_and_b32 v6, 4, v6
    v_xor_b32 v5, v5, v6
    v_lshlrev_b32 v5, 4, v5
    v_lshl_add_u32 v8, v4, 7, v5
    s_lshl_b32 s35, s27, 16
    s_lshl_b32 s33, s24, 18
    s_add_u32 s33, s33, s35
    s_lshl_b32 s34, s25, 18
    s_add_u32 s34, s34, s35
    s_lshl_b32 s50, s27, 13
    s_cmp_lg_u32 s60, 0
    s_cbranch_scc1 m1_lw0
    s_barrier
m1_lw0:
    s_mov_b32 s54, s50
    s_add_u32 s51, s50, 131072
m1_lw:
    s_add_u32 m0, s50, 4096
    s_add_u32 s35, s34, 0
    buffer_load_dwordx4 v8, s[16:19], s35 offen sc1 lds
    s_add_u32 m0, s50, 5120
    s_add_u32 s35, s34, 1024
    buffer_load_dwordx4 v8, s[16:19], s35 offen sc1 lds
    s_add_u32 m0, s50, 6144
    s_add_u32 s35, s34, 2048
    buffer_load_dwordx4 v8, s[16:19], s35 offen sc1 lds
    s_add_u32 m0, s50, 7168
    s_add_u32 s35, s34, 3072
    buffer_load_dwordx4 v8, s[16:19], s35 offen sc1 lds
    s_add_u32 s34, s34, 4096
    s_add_u32 s50, s50, 32768
    s_cmp_lg_u32 s50, s51
    s_cbranch_scc1 m1_lw
    s_mov_b32 s50, s54
    s_mov_b32 s53, 0
    s_cmp_eq_u32 s60, 0
    s_cbranch_scc1 m1_la
    s_barrier
m1_la:
    s_add_u32 m0, s50, 0
    s_add_u32 s35, s33, 0
    buffer_load_dwordx4 v8, s[20:23], s35 offen sc1 lds
    s_add_u32 m0, s50, 1024
    s_add_u32 s35, s33, 1024
    buffer_load_dwordx4 v8, s[20:23], s35 offen sc1 lds
    s_add_u32 m0, s50, 2048
    s_add_u32 s35, s33, 2048
    buffer_load_dwordx4 v8, s[20:23], s35 offen sc1 lds
    s_add_u32 m0, s50, 3072
    s_add_u32 s35, s33, 3072
    buffer_load_dwordx4 v8, s[20:23], s35 offen sc1 lds
    s_add_u32 s33, s33, 4096
    s_add_u32 s50, s50, 32768
    s_add_u32 s53, s53, 1
    s_cmp_lg_u32 s53, 2
    s_cbranch_scc1 m1_lb
    s_waitcnt vmcnt(4)
    s_barrier
m1_lb:
    s_cmp_lt_u32 s53, 4
    s_cbranch_scc1 m1_la
    s_mov_b32 s50, s54
    s_mov_b32 s53, 1
    s_waitcnt vmcnt(8)
    s_branch m1_l2
m1_l1:
    s_waitcnt vmcnt(16)
    s_cmp_lg_u32 s53, 2
    s_cbranch_scc1 m1_l2
    s_waitcnt vmcnt(12)
m1_l2:
    s_barrier
    s_add_u32 m0, s50, 0
    s_add_u32 s35, s33, 0
    buffer_load_dwordx4 v8, s[20:23], s35 offen sc1 lds
    s_add_u32 m0, s50, 1024
    s_add_u32 s35, s33, 1024
    buffer_load_dwordx4 v8, s[20:23], s35 offen sc1 lds
    s_add_u32 m0, s50, 2048
    s_add_u32 s35, s33, 2048
    buffer_load_dwordx4 v8, s[20:23], s35 offen sc1 lds
    s_add_u32 m0, s50, 3072
    s_add_u32 s35, s33, 3072
    buffer_load_dwordx4 v8, s[20:23], s35 offen sc1 lds
    s_add_u32 m0, s50, 4096
    s_add_u32 s35, s34, 0
    buffer_load_dwordx4 v8, s[16:19], s35 offen sc1 lds
    s_add_u32 m0, s50, 5120
    s_add_u32 s35, s34, 1024
    buffer_load_dwordx4 v8, s[16:19], s35 offen sc1 lds
    s_add_u32 m0, s50, 6144
    s_add_u32 s35, s34, 2048
    buffer_load_dwordx4 v8, s[16:19], s35 offen sc1 lds
    s_add_u32 m0, s50, 7168
    s_add_u32 s35, s34, 3072
    buffer_load_dwordx4 v8, s[16:19], s35 offen sc1 lds
    s_add_u32 s33, s33, 4096
    s_add_u32 s34, s34, 4096
    s_add_u32 s50, s50, 32768
    s_cmp_eq_u32 s50, s51
    s_cselect_b32 s50, s54, s50
    s_add_u32 s53, s53, 1
    s_cmp_le_u32 s53, 12
    s_cbranch_scc1 m1_l1
    s_waitcnt vmcnt(16)
    s_barrier
    s_waitcnt vmcnt(8)
    s_barrier
    s_waitcnt vmcnt(0)
    s_barrier
    s_waitcnt vmcnt(0)
    s_barrier
    s_branch m1_final
m1_lskip:
    s_barrier
    s_barrier
    s_branch m2_loader
m1_cskip:
    s_mov_b32 s92, 65536
    s_lshl_b32 s91, s26, 10
    s_add_u32 s90, s90, s91
woxs_pl:
    buffer_load_dword v244, v240, s[12:15], s90 offen sc1
    s_waitcnt vmcnt(0)
    v_cmp_eq_u32 vcc, 0, v244
    s_nop 1
    s_cmp_eq_u64 vcc, 0
    s_cbranch_scc1 woxs_px
    s_sub_u32 s92, s92, 1
    s_cmp_lg_u32 s92, 0
    s_cbranch_scc1 woxs_pl
woxs_px:
    s_mov_b64 exec, -1
woxs_np:
    s_barrier
    s_branch m1_sync
m1_compute:
    s_cmp_ge_u32 s2, 240
    s_cbranch_scc1 m1_cskip
    s_load_dwordx2 s[10:11], s[0:1], 40
    s_and_b32 s27, s2, 7
    s_lshr_b32 s28, s2, 3
    s_mul_i32 s29, s28, 52429
    s_lshr_b32 s29, s29, 18
    s_mul_i32 s31, s29, 5
    s_sub_u32 s28, s28, s31
    s_and_b32 s31, s27, 1
    s_mul_i32 s31, s31, 5
    s_add_u32 s24, s31, s28
    s_lshr_b32 s31, s27, 1
    s_mul_i32 s31, s31, 6
    s_add_u32 s25, s31, s29
    s_add_u32 s55, s28, s29
    s_mul_i32 s55, s55, 0
    s_and_b32 s55, s55, 15
    s_lshl_b32 s38, s25, 7
    s_lshl_b32 s39, s26, 4
    s_add_u32 s38, s38, s39
    s_waitcnt lgkmcnt(0)
    s_add_u32 s10, s10, s38
    s_addc_u32 s11, s11, 0
    s_load_dwordx4 s[56:59], s[10:11], 0
    s_lshl_b32 s40, s60, 14
    s_add_u32 s40, s40, 17694720
    v_lshlrev_b32 v3, 4, v2
    s_lshl_b32 s36, s26, 12
    s_add_u32 s37, s36, s40
    s_lshl_b32 s30, s26, 13
    v_and_b32 v5, 15, v2
    v_lshrrev_b32 v4, 5, v2
    v_lshrrev_b32 v6, 2, v5
    v_lshl_add_u32 v6, v4, 3, v6
    v_lshlrev_b32 v6, 7, v6
    v_lshrrev_b32 v7, 3, v5
    v_lshl_add_u32 v6, v7, 6, v6
    v_and_b32 v7, 16, v2
    v_lshl_add_u32 v6, v7, 1, v6
    v_and_b32 v7, 3, v2
    v_lshl_add_u32 v6, v7, 3, v6
    v_xor_b32 v9, 64, v6
    v_add_u32 v8, s30, v6
    v_add_u32 v9, s30, v9
    v_mov_b32 v10, v8
    v_mov_b32 v11, v9
    s_add_u32 s36, s36, 131072
    v_lshl_add_u32 v14, v4, 5, s36
    s_lshl_b32 s55, s55, 7
    v_add_u32 v12, s55, v14
    v_lshl_add_u32 v13, v2, 3, s36
    v_mov_b32 v64, 0
    v_mov_b32 v65, 0
    v_mov_b32 v66, 0
    v_mov_b32 v67, 0
    v_mov_b32 v68, 0
    v_mov_b32 v69, 0
    v_mov_b32 v70, 0
    v_mov_b32 v71, 0
    v_mov_b32 v72, 0
    v_mov_b32 v73, 0
    v_mov_b32 v74, 0
    v_mov_b32 v75, 0
    v_mov_b32 v76, 0
    v_mov_b32 v77, 0
    v_mov_b32 v78, 0
    v_mov_b32 v79, 0
    v_mov_b32 v80, 0
    v_mov_b32 v81, 0
    v_mov_b32 v82, 0
    v_mov_b32 v83, 0
    v_mov_b32 v84, 0
    v_mov_b32 v85, 0
    v_mov_b32 v86, 0
    v_mov_b32 v87, 0
    v_mov_b32 v88, 0
    v_mov_b32 v89, 0
    v_mov_b32 v90, 0
    v_mov_b32 v91, 0
    v_mov_b32 v92, 0
    v_mov_b32 v93, 0
    v_mov_b32 v94, 0
    v_mov_b32 v95, 0
    v_mov_b32 v96, 0
    v_mov_b32 v97, 0
    v_mov_b32 v98, 0
    v_mov_b32 v99, 0
    v_mov_b32 v100, 0
    v_mov_b32 v101, 0
    v_mov_b32 v102, 0
    v_mov_b32 v103, 0
    v_mov_b32 v104, 0
    v_mov_b32 v105, 0
    v_mov_b32 v106, 0
    v_mov_b32 v107, 0
    v_mov_b32 v108, 0
    v_mov_b32 v109, 0
    v_mov_b32 v110, 0
    v_mov_b32 v111, 0
    v_mov_b32 v112, 0
    v_mov_b32 v113, 0
    v_mov_b32 v114, 0
    v_mov_b32 v115, 0
    v_mov_b32 v116, 0
    v_mov_b32 v117, 0
    v_mov_b32 v118, 0
    v_mov_b32 v119, 0
    v_mov_b32 v120, 0
    v_mov_b32 v121, 0
    v_mov_b32 v122, 0
    v_mov_b32 v123, 0
    v_mov_b32 v124, 0
    v_mov_b32 v125, 0
    v_mov_b32 v126, 0
    v_mov_b32 v127, 0
    s_mov_b32 s92, 65536
    s_lshl_b32 s91, s26, 10
    s_add_u32 s90, s90, s91
wox_pl:
    buffer_load_dword v244, v240, s[12:15], s90 offen sc1
    s_waitcnt vmcnt(0)
    v_cmp_eq_u32 vcc, 0, v244
    s_nop 1
    s_cmp_eq_u64 vcc, 0
    s_cbranch_scc1 wox_px
    s_sub_u32 s92, s92, 1
    s_cmp_lg_u32 s92, 0
    s_cbranch_scc1 wox_pl
wox_px:
    s_mov_b64 exec, -1
wox_np:
    s_barrier
    buffer_load_dwordx4 v[16:19], v3, s[12:15], s37 offen offset:0 sc1
    buffer_load_dwordx4 v[20:23], v3, s[12:15], s37 offen offset:1024 sc1
    buffer_load_dwordx4 v[24:27], v3, s[12:15], s37 offen offset:2048 sc1
    buffer_load_dwordx4 v[28:31], v3, s[12:15], s37 offen offset:3072 sc1
    s_waitcnt vmcnt(0)
    s_mov_b32 s38, 0x3acccccd
    s_mov_b32 s39, 0x3727c5ac
    v_mul_f32 v16, s38, v16
    v_mul_f32 v17, s38, v17
    v_mul_f32 v18, s38, v18
    v_mul_f32 v19, s38, v19
    v_mul_f32 v20, s38, v20
    v_mul_f32 v21, s38, v21
    v_mul_f32 v22, s38, v22
    v_mul_f32 v23, s38, v23
    v_mul_f32 v24, s38, v24
    v_mul_f32 v25, s38, v25
    v_mul_f32 v26, s38, v26
    v_mul_f32 v27, s38, v27
    v_mul_f32 v28, s38, v28
    v_mul_f32 v29, s38, v29
    v_mul_f32 v30, s38, v30
    v_mul_f32 v31, s38, v31
    v_fma_f32 v17, -v16, v16, v17
    v_fma_f32 v19, -v18, v18, v19
    v_fma_f32 v21, -v20, v20, v21
    v_fma_f32 v23, -v22, v22, v23
    v_fma_f32 v25, -v24, v24, v25
    v_fma_f32 v27, -v26, v26, v27
    v_fma_f32 v29, -v28, v28, v29
    v_fma_f32 v31, -v30, v30, v31
    v_max_f32 v17, 0, v17
    v_max_f32 v19, 0, v19
    v_max_f32 v21, 0, v21
    v_max_f32 v23, 0, v23
    v_max_f32 v25, 0, v25
    v_max_f32 v27, 0, v27
    v_max_f32 v29, 0, v29
    v_max_f32 v31, 0, v31
    v_add_f32 v32, s39, v17
    v_add_f32 v33, s39, v19
    v_add_f32 v34, s39, v21
    v_add_f32 v35, s39, v23
    v_add_f32 v36, s39, v25
    v_add_f32 v37, s39, v27
    v_add_f32 v38, s39, v29
    v_add_f32 v39, s39, v31
    v_rsq_f32 v32, v32
    v_rsq_f32 v33, v33
    v_rsq_f32 v34, v34
    v_rsq_f32 v35, v35
    v_rsq_f32 v36, v36
    v_rsq_f32 v37, v37
    v_rsq_f32 v38, v38
    v_rsq_f32 v39, v39
    v_mul_f32 v40, v32, v32
    v_mul_f32 v41, v33, v33
    v_mul_f32 v42, v34, v34
    v_mul_f32 v43, v35, v35
    v_mul_f32 v44, v36, v36
    v_mul_f32 v45, v37, v37
    v_mul_f32 v46, v38, v38
    v_mul_f32 v47, v39, v39
    v_fma_f32 v40, v40, v17, s39
    v_fma_f32 v41, v41, v19, s39
    v_fma_f32 v42, v42, v21, s39
    v_fma_f32 v43, v43, v23, s39
    v_fma_f32 v44, v44, v25, s39
    v_fma_f32 v45, v45, v27, s39
    v_fma_f32 v46, v46, v29, s39
    v_fma_f32 v47, v47, v31, s39
    v_rsq_f32 v40, v40
    v_rsq_f32 v41, v41
    v_rsq_f32 v42, v42
    v_rsq_f32 v43, v43
    v_rsq_f32 v44, v44
    v_rsq_f32 v45, v45
    v_rsq_f32 v46, v46
    v_rsq_f32 v47, v47
    v_mul_f32 v32, v32, v40
    v_mul_f32 v33, v33, v41
    v_mul_f32 v34, v34, v42
    v_mul_f32 v35, v35, v43
    v_mul_f32 v36, v36, v44
    v_mul_f32 v37, v37, v45
    v_mul_f32 v38, v38, v46
    v_mul_f32 v39, v39, v47
    v_mul_f32 v40, -v16, v32
    v_mul_f32 v41, -v18, v33
    v_mul_f32 v42, -v20, v34
    v_mul_f32 v43, -v22, v35
    v_mul_f32 v44, -v24, v36
    v_mul_f32 v45, -v26, v37
    v_mul_f32 v46, -v28, v38
    v_mul_f32 v47, -v30, v39
    ds_write_b64 v13, v[32:33] offset:0
    ds_write_b64 v13, v[40:41] offset:2048
    ds_write_b64 v13, v[34:35] offset:512
    ds_write_b64 v13, v[42:43] offset:2560
    ds_write_b64 v13, v[36:37] offset:1024
    ds_write_b64 v13, v[44:45] offset:3072
    ds_write_b64 v13, v[38:39] offset:1536
    ds_write_b64 v13, v[46:47] offset:3584
    s_waitcnt lgkmcnt(0)
    s_mov_b32 s50, 0
    s_mov_b32 s53, 16
    s_mov_b32 s38, 0xffff0000
    s_barrier
    ds_read_b64_tr_b16 v[128:129], v10 offset:0
    ds_read_b64_tr_b16 v[130:131], v10 offset:512
    ds_read_b64_tr_b16 v[132:133], v11 offset:0
    ds_read_b64_tr_b16 v[134:135], v11 offset:512
    ds_read_b128 v[160:163], v12 offset:0
    ds_read_b128 v[164:167], v12 offset:16
    ds_read_b128 v[168:171], v12 offset:2048
    ds_read_b128 v[172:175], v12 offset:2064
    ds_read_b64_tr_b16 v[144:145], v10 offset:4096
    ds_read_b64_tr_b16 v[146:147], v10 offset:4608
    ds_read_b64_tr_b16 v[148:149], v11 offset:4096
    ds_read_b64_tr_b16 v[150:151], v11 offset:4608
    ds_read_b64_tr_b16 v[136:137], v10 offset:2048
    ds_read_b64_tr_b16 v[138:139], v10 offset:2560
    ds_read_b64_tr_b16 v[140:141], v11 offset:2048
    ds_read_b64_tr_b16 v[142:143], v11 offset:2560
    ds_read_b128 v[176:179], v12 offset:64
    ds_read_b128 v[180:183], v12 offset:80
    ds_read_b128 v[184:187], v12 offset:2112
    ds_read_b128 v[188:191], v12 offset:2128
    ds_read_b64_tr_b16 v[152:153], v10 offset:6144
    ds_read_b64_tr_b16 v[154:155], v10 offset:6656
    ds_read_b64_tr_b16 v[156:157], v11 offset:6144
    ds_read_b64_tr_b16 v[158:159], v11 offset:6656
    v_mov_b32 v204, 0
    v_mov_b32 v205, 0
    v_mov_b32 v206, 0
    v_mov_b32 v207, 0
    v_mov_b32 v216, 0
    v_mov_b32 v217, 0
    v_mov_b32 v218, 0
    v_mov_b32 v219, 0
    v_mov_b32 v220, 0
    v_mov_b32 v221, 0
    v_mov_b32 v222, 0
    v_mov_b32 v223, 0
m1_cl:
    s_add_u32 s50, s50, 32768
    s_and_b32 s50, s50, 0x1ffff
    s_add_u32 s55, s55, 128
    s_and_b32 s55, s55, 2047
    v_add_u32 v10, s50, v8
    v_add_u32 v11, s50, v9
    v_add_u32 v12, s55, v14
    s_waitcnt lgkmcnt(0)
    s_barrier
    v_mfma_f32_32x32x16_bf16 v[96:111], v[216:219], v[204:207], v[96:111]
    ds_read_b64_tr_b16 v[192:193], v10 offset:0
    ds_read_b64_tr_b16 v[194:195], v10 offset:512
    ds_read_b64_tr_b16 v[196:197], v11 offset:0
    v_lshlrev_b32 v16, 16, v128
    v_and_b32 v17, s38, v128
    v_lshlrev_b32 v18, 16, v129
    v_and_b32 v19, s38, v129
    v_lshlrev_b32 v20, 16, v130
    v_and_b32 v21, s38, v130
    v_lshlrev_b32 v22, 16, v131
    v_and_b32 v23, s38, v131
    v_fma_f32 v16, v16, v160, v168
    v_fma_f32 v17, v17, v161, v169
    v_mfma_f32_32x32x16_bf16 v[112:127], v[220:223], v[204:207], v[112:127]
    ds_read_b64_tr_b16 v[198:199], v11 offset:512
    ds_read_b128 v[224:227], v12 offset:0
    ds_read_b128 v[228:231], v12 offset:16
    v_fma_f32 v18, v18, v162, v170
    v_fma_f32 v19, v19, v163, v171
    v_fma_f32 v20, v20, v164, v172
    v_fma_f32 v21, v21, v165, v173
    v_fma_f32 v22, v22, v166, v174
    v_fma_f32 v23, v23, v167, v175
    v_cvt_pk_bf16_f32 v128, v16, v17
    v_cvt_pk_bf16_f32 v129, v18, v19
    v_cvt_pk_bf16_f32 v130, v20, v21
    v_cvt_pk_bf16_f32 v131, v22, v23
    s_nop 1
    v_mfma_f32_32x32x16_bf16 v[64:79], v[144:147], v[128:131], v[64:79]
    ds_read_b128 v[232:235], v12 offset:2048
    ds_read_b128 v[236:239], v12 offset:2064
    ds_read_b64_tr_b16 v[208:209], v10 offset:4096
    v_lshlrev_b32 v24, 16, v132
    v_and_b32 v25, s38, v132
    v_lshlrev_b32 v26, 16, v133
    v_and_b32 v27, s38, v133
    v_lshlrev_b32 v28, 16, v134
    v_and_b32 v29, s38, v134
    v_lshlrev_b32 v30, 16, v135
    v_and_b32 v31, s38, v135
    v_fma_f32 v24, v24, v160, v168
    v_fma_f32 v25, v25, v161, v169
    v_mfma_f32_32x32x16_bf16 v[80:95], v[148:151], v[128:131], v[80:95]
    ds_read_b64_tr_b16 v[210:211], v10 offset:4608
    ds_read_b64_tr_b16 v[212:213], v11 offset:4096
    ds_read_b64_tr_b16 v[214:215], v11 offset:4608
    v_fma_f32 v26, v26, v162, v170
    v_fma_f32 v27, v27, v163, v171
    v_fma_f32 v28, v28, v164, v172
    v_fma_f32 v29, v29, v165, v173
    v_fma_f32 v30, v30, v166, v174
    v_fma_f32 v31, v31, v167, v175
    v_cvt_pk_bf16_f32 v132, v24, v25
    v_cvt_pk_bf16_f32 v133, v26, v27
    v_cvt_pk_bf16_f32 v134, v28, v29
    v_cvt_pk_bf16_f32 v135, v30, v31
    s_nop 1
    v_mfma_f32_32x32x16_bf16 v[96:111], v[144:147], v[132:135], v[96:111]
    ds_read_b64_tr_b16 v[200:201], v10 offset:2048
    ds_read_b64_tr_b16 v[202:203], v10 offset:2560
    ds_read_b64_tr_b16 v[204:205], v11 offset:2048
    v_lshlrev_b32 v32, 16, v136
    v_and_b32 v33, s38, v136
    v_lshlrev_b32 v34, 16, v137
    v_and_b32 v35, s38, v137
    v_lshlrev_b32 v36, 16, v138
    v_and_b32 v37, s38, v138
    v_lshlrev_b32 v38, 16, v139
    v_and_b32 v39, s38, v139
    v_fma_f32 v32, v32, v176, v184
    v_fma_f32 v33, v33, v177, v185
    v_mfma_f32_32x32x16_bf16 v[112:127], v[148:151], v[132:135], v[112:127]
    ds_read_b64_tr_b16 v[206:207], v11 offset:2560
    ds_read_b128 v[240:243], v12 offset:64
    ds_read_b128 v[244:247], v12 offset:80
    v_fma_f32 v34, v34, v178, v186
    v_fma_f32 v35, v35, v179, v187
    v_fma_f32 v36, v36, v180, v188
    v_fma_f32 v37, v37, v181, v189
    v_fma_f32 v38, v38, v182, v190
    v_fma_f32 v39, v39, v183, v191
    v_cvt_pk_bf16_f32 v136, v32, v33
    v_cvt_pk_bf16_f32 v137, v34, v35
    v_cvt_pk_bf16_f32 v138, v36, v37
    v_cvt_pk_bf16_f32 v139, v38, v39
    s_nop 1
    v_mfma_f32_32x32x16_bf16 v[64:79], v[152:155], v[136:139], v[64:79]
    ds_read_b128 v[248:251], v12 offset:2112
    ds_read_b128 v[252:255], v12 offset:2128
    ds_read_b64_tr_b16 v[216:217], v10 offset:6144
    v_lshlrev_b32 v40, 16, v140
    v_and_b32 v41, s38, v140
    v_lshlrev_b32 v42, 16, v141
    v_and_b32 v43, s38, v141
    v_lshlrev_b32 v44, 16, v142
    v_and_b32 v45, s38, v142
    v_lshlrev_b32 v46, 16, v143
    v_and_b32 v47, s38, v143
    v_fma_f32 v40, v40, v176, v184
    v_fma_f32 v41, v41, v177, v185
    v_mfma_f32_32x32x16_bf16 v[80:95], v[156:159], v[136:139], v[80:95]
    ds_read_b64_tr_b16 v[218:219], v10 offset:6656
    ds_read_b64_tr_b16 v[220:221], v11 offset:6144
    ds_read_b64_tr_b16 v[222:223], v11 offset:6656
    v_fma_f32 v42, v42, v178, v186
    v_fma_f32 v43, v43, v179, v187
    v_fma_f32 v44, v44, v180, v188
    v_fma_f32 v45, v45, v181, v189
    v_fma_f32 v46, v46, v182, v190
    v_fma_f32 v47, v47, v183, v191
    v_cvt_pk_bf16_f32 v140, v40, v41
    v_cvt_pk_bf16_f32 v141, v42, v43
    v_cvt_pk_bf16_f32 v142, v44, v45
    v_cvt_pk_bf16_f32 v143, v46, v47
    s_sub_u32 s53, s53, 1
    s_cmp_eq_u32 s53, 0
    s_add_u32 s50, s50, 32768
    s_and_b32 s50, s50, 0x1ffff
    s_add_u32 s55, s55, 128
    s_and_b32 s55, s55, 2047
    v_add_u32 v10, s50, v8
    v_add_u32 v11, s50, v9
    v_add_u32 v12, s55, v14
    s_waitcnt lgkmcnt(0)
    s_barrier
    v_mfma_f32_32x32x16_bf16 v[96:111], v[152:155], v[140:143], v[96:111]
    ds_read_b64_tr_b16 v[128:129], v10 offset:0
    ds_read_b64_tr_b16 v[130:131], v10 offset:512
    ds_read_b64_tr_b16 v[132:133], v11 offset:0
    v_lshlrev_b32 v16, 16, v192
    v_and_b32 v17, s38, v192
    v_lshlrev_b32 v18, 16, v193
    v_and_b32 v19, s38, v193
    v_lshlrev_b32 v20, 16, v194
    v_and_b32 v21, s38, v194
    v_lshlrev_b32 v22, 16, v195
    v_and_b32 v23, s38, v195
    v_fma_f32 v16, v16, v224, v232
    v_fma_f32 v17, v17, v225, v233
    v_mfma_f32_32x32x16_bf16 v[112:127], v[156:159], v[140:143], v[112:127]
    ds_read_b64_tr_b16 v[134:135], v11 offset:512
    ds_read_b128 v[160:163], v12 offset:0
    ds_read_b128 v[164:167], v12 offset:16
    v_fma_f32 v18, v18, v226, v234
    v_fma_f32 v19, v19, v227, v235
    v_fma_f32 v20, v20, v228, v236
    v_fma_f32 v21, v21, v229, v237
    v_fma_f32 v22, v22, v230, v238
    v_fma_f32 v23, v23, v231, v239
    v_cvt_pk_bf16_f32 v192, v16, v17
    v_cvt_pk_bf16_f32 v193, v18, v19
    v_cvt_pk_bf16_f32 v194, v20, v21
    v_cvt_pk_bf16_f32 v195, v22, v23
    s_nop 1
    v_mfma_f32_32x32x16_bf16 v[64:79], v[208:211], v[192:195], v[64:79]
    ds_read_b128 v[168:171], v12 offset:2048
    ds_read_b128 v[172:175], v12 offset:2064
    ds_read_b64_tr_b16 v[144:145], v10 offset:4096
    v_lshlrev_b32 v24, 16, v196
    v_and_b32 v25, s38, v196
    v_lshlrev_b32 v26, 16, v197
    v_and_b32 v27, s38, v197
    v_lshlrev_b32 v28, 16, v198
    v_and_b32 v29, s38, v198
    v_lshlrev_b32 v30, 16, v199
    v_and_b32 v31, s38, v199
    v_fma_f32 v24, v24, v224, v232
    v_fma_f32 v25, v25, v225, v233
    v_mfma_f32_32x32x16_bf16 v[80:95], v[212:215], v[192:195], v[80:95]
    ds_read_b64_tr_b16 v[146:147], v10 offset:4608
    ds_read_b64_tr_b16 v[148:149], v11 offset:4096
    ds_read_b64_tr_b16 v[150:151], v11 offset:4608
    v_fma_f32 v26, v26, v226, v234
    v_fma_f32 v27, v27, v227, v235
    v_fma_f32 v28, v28, v228, v236
    v_fma_f32 v29, v29, v229, v237
    v_fma_f32 v30, v30, v230, v238
    v_fma_f32 v31, v31, v231, v239
    v_cvt_pk_bf16_f32 v196, v24, v25
    v_cvt_pk_bf16_f32 v197, v26, v27
    v_cvt_pk_bf16_f32 v198, v28, v29
    v_cvt_pk_bf16_f32 v199, v30, v31
    s_nop 1
    v_mfma_f32_32x32x16_bf16 v[96:111], v[208:211], v[196:199], v[96:111]
    ds_read_b64_tr_b16 v[136:137], v10 offset:2048
    ds_read_b64_tr_b16 v[138:139], v10 offset:2560
    ds_read_b64_tr_b16 v[140:141], v11 offset:2048
    v_lshlrev_b32 v32, 16, v200
    v_and_b32 v33, s38, v200
    v_lshlrev_b32 v34, 16, v201
    v_and_b32 v35, s38, v201
    v_lshlrev_b32 v36, 16, v202
    v_and_b32 v37, s38, v202
    v_lshlrev_b32 v38, 16, v203
    v_and_b32 v39, s38, v203
    v_fma_f32 v32, v32, v240, v248
    v_fma_f32 v33, v33, v241, v249
    v_mfma_f32_32x32x16_bf16 v[112:127], v[212:215], v[196:199], v[112:127]
    ds_read_b64_tr_b16 v[142:143], v11 offset:2560
    ds_read_b128 v[176:179], v12 offset:64
    ds_read_b128 v[180:183], v12 offset:80
    v_fma_f32 v34, v34, v242, v250
    v_fma_f32 v35, v35, v243, v251
    v_fma_f32 v36, v36, v244, v252
    v_fma_f32 v37, v37, v245, v253
    v_fma_f32 v38, v38, v246, v254
    v_fma_f32 v39, v39, v247, v255
    v_cvt_pk_bf16_f32 v200, v32, v33
    v_cvt_pk_bf16_f32 v201, v34, v35
    v_cvt_pk_bf16_f32 v202, v36, v37
    v_cvt_pk_bf16_f32 v203, v38, v39
    s_nop 1
    v_mfma_f32_32x32x16_bf16 v[64:79], v[216:219], v[200:203], v[64:79]
    ds_read_b128 v[184:187], v12 offset:2112
    ds_read_b128 v[188:191], v12 offset:2128
    ds_read_b64_tr_b16 v[152:153], v10 offset:6144
    v_lshlrev_b32 v40, 16, v204
    v_and_b32 v41, s38, v204
    v_lshlrev_b32 v42, 16, v205
    v_and_b32 v43, s38, v205
    v_lshlrev_b32 v44, 16, v206
    v_and_b32 v45, s38, v206
    v_lshlrev_b32 v46, 16, v207
    v_and_b32 v47, s38, v207
    v_fma_f32 v40, v40, v240, v248
    v_fma_f32 v41, v41, v241, v249
    v_mfma_f32_32x32x16_bf16 v[80:95], v[220:223], v[200:203], v[80:95]
    ds_read_b64_tr_b16 v[154:155], v10 offset:6656
    ds_read_b64_tr_b16 v[156:157], v11 offset:6144
    ds_read_b64_tr_b16 v[158:159], v11 offset:6656
    v_fma_f32 v42, v42, v242, v250
    v_fma_f32 v43, v43, v243, v251
    v_fma_f32 v44, v44, v244, v252
    v_fma_f32 v45, v45, v245, v253
    v_fma_f32 v46, v46, v246, v254
    v_fma_f32 v47, v47, v247, v255
    v_cvt_pk_bf16_f32 v204, v40, v41
    v_cvt_pk_bf16_f32 v205, v42, v43
    v_cvt_pk_bf16_f32 v206, v44, v45
    v_cvt_pk_bf16_f32 v207, v46, v47
    s_sub_u32 s53, s53, 1
    s_cmp_eq_u32 s53, 0
    s_cbranch_scc0 m1_cl
    v_mfma_f32_32x32x16_bf16 v[96:111], v[216:219], v[204:207], v[96:111]
    v_mfma_f32_32x32x16_bf16 v[112:127], v[220:223], v[204:207], v[112:127]
    s_waitcnt lgkmcnt(0)
    v_and_b32 v5, 31, v2
    v_mul_u32_u24 v5, 272, v5
    v_lshl_add_u32 v5, v4, 4, v5
    s_mul_i32 s30, s26, 17408
    v_add_u32 v5, s30, v5
    ds_write_b128 v5, v[64:67] offset:0
    ds_write_b128 v5, v[68:71] offset:32
    ds_write_b128 v5, v[72:75] offset:64
    ds_write_b128 v5, v[76:79] offset:96
    ds_write_b128 v5, v[80:83] offset:128
    ds_write_b128 v5, v[84:87] offset:160
    ds_write_b128 v5, v[88:91] offset:192
    ds_write_b128 v5, v[92:95] offset:224
    ds_write_b128 v5, v[96:99] offset:8704
    ds_write_b128 v5, v[100:103] offset:8736
    ds_write_b128 v5, v[104:107] offset:8768
    ds_write_b128 v5, v[108:111] offset:8800
    ds_write_b128 v5, v[112:115] offset:8832
    ds_write_b128 v5, v[116:119] offset:8864
    ds_write_b128 v5, v[120:123] offset:8896
    ds_write_b128 v5, v[124:127] offset:8928
m1_final:
    v_mul_u32_u24 v6, 272, v2
    s_lshl_b32 s35, s26, 5
    v_add_u32 v6, s35, v6
    s_waitcnt lgkmcnt(0)
    s_barrier
    ds_read_b128 v[64:67], v6 offset:0
    ds_read_b128 v[68:71], v6 offset:16
    ds_read_b128 v[72:75], v6 offset:17408
    ds_read_b128 v[76:79], v6 offset:17424
    ds_read_b128 v[80:83], v6 offset:34816
    ds_read_b128 v[84:87], v6 offset:34832
    ds_read_b128 v[88:91], v6 offset:52224
    ds_read_b128 v[92:95], v6 offset:52240
    s_lshl_b32 s44, s56, 16
    s_and_b32 s45, s56, 0xffff0000
    s_lshl_b32 s46, s57, 16
    s_and_b32 s47, s57, 0xffff0000
    s_lshl_b32 s48, s58, 16
    s_and_b32 s49, s58, 0xffff0000
    s_lshl_b32 s50, s59, 16
    s_and_b32 s51, s59, 0xffff0000
    s_lshl_b32 s35, s24, 6
    v_add_u32 v8, s35, v2
    v_mul_u32_u24 v9, 52429, v8
    v_lshrrev_b32 v9, 22, v9
    v_mul_u32_u24 v10, 80, v9
    v_sub_u32 v8, v8, v10
    v_lshrrev_b32 v10, 5, v8
    v_lshlrev_b32 v10, 1, v10
    v_bfe_u32 v11, v8, 2, 1
    v_add_u32 v11, v11, v10
    v_bfe_u32 v12, v8, 3, 2
    v_and_b32 v13, 3, v8
    v_lshl_add_u32 v12, v12, 2, v13
    v_and_b32 v13, 15, v8
    v_cmp_gt_u32 vcc, 64, v8
    s_nop 1
    v_cndmask_b32 v11, 4, v11, vcc
    v_cndmask_b32 v12, v13, v12, vcc
    v_mad_u32_u24 v11, v9, 5, v11
    v_mul_u32_u24 v11, 49152, v11
    v_lshl_add_u32 v8, v12, 4, v11
    s_lshl_b32 s35, s25, 11
    s_lshl_b32 s36, s26, 8
    s_add_u32 s35, s35, s36
    s_add_u32 s35, s35, 15728640
    s_waitcnt lgkmcnt(6)
    v_add_f32 v16, s44, v64
    v_add_f32 v17, s45, v65
    v_add_f32 v18, s46, v66
    v_add_f32 v19, s47, v67
    v_add_f32 v20, s48, v68
    v_add_f32 v21, s49, v69
    v_add_f32 v22, s50, v70
    v_add_f32 v23, s51, v71
    s_waitcnt lgkmcnt(4)
    v_add_f32 v16, v72, v16
    v_add_f32 v17, v73, v17
    v_add_f32 v18, v74, v18
    v_add_f32 v19, v75, v19
    v_add_f32 v20, v76, v20
    v_add_f32 v21, v77, v21
    v_add_f32 v22, v78, v22
    v_add_f32 v23, v79, v23
    s_waitcnt lgkmcnt(2)
    v_add_f32 v16, v80, v16
    v_add_f32 v17, v81, v17
    v_add_f32 v18, v82, v18
    v_add_f32 v19, v83, v19
    v_add_f32 v20, v84, v20
    v_add_f32 v21, v85, v21
    v_add_f32 v22, v86, v22
    v_add_f32 v23, v87, v23
    s_waitcnt lgkmcnt(0)
    v_add_f32 v16, v88, v16
    v_add_f32 v17, v89, v17
    v_add_f32 v18, v90, v18
    v_add_f32 v19, v91, v19
    v_add_f32 v20, v92, v20
    v_add_f32 v21, v93, v21
    v_add_f32 v22, v94, v22
    v_add_f32 v23, v95, v23
    s_mov_b32 s36, 0xbdd2d3e8
    v_mov_b32 v40, 0xc0135761
    v_mul_f32 v24, v16, v16
    v_mul_f32 v25, v17, v17
    v_mul_f32 v26, v18, v18
    v_mul_f32 v27, v19, v19
    v_mul_f32 v28, v20, v20
    v_mul_f32 v29, v21, v21
    v_mul_f32 v30, v22, v22
    v_mul_f32 v31, v23, v23
    v_fma_f32 v24, v24, s36, v40
    v_fma_f32 v25, v25, s36, v40
    v_fma_f32 v26, v26, s36, v40
    v_fma_f32 v27, v27, s36, v40
    v_fma_f32 v28, v28, s36, v40
    v_fma_f32 v29, v29, s36, v40
    v_fma_f32 v30, v30, s36, v40
    v_fma_f32 v31, v31, s36, v40
    v_mul_f32 v24, v24, v16
    v_mul_f32 v25, v25, v17
    v_mul_f32 v26, v26, v18
    v_mul_f32 v27, v27, v19
    v_mul_f32 v28, v28, v20
    v_mul_f32 v29, v29, v21
    v_mul_f32 v30, v30, v22
    v_mul_f32 v31, v31, v23
    v_exp_f32 v24, v24
    v_exp_f32 v25, v25
    v_exp_f32 v26, v26
    v_exp_f32 v27, v27
    v_exp_f32 v28, v28
    v_exp_f32 v29, v29
    v_exp_f32 v30, v30
    v_exp_f32 v31, v31
    v_add_f32 v24, 1.0, v24
    v_add_f32 v25, 1.0, v25
    v_add_f32 v26, 1.0, v26
    v_add_f32 v27, 1.0, v27
    v_add_f32 v28, 1.0, v28
    v_add_f32 v29, 1.0, v29
    v_add_f32 v30, 1.0, v30
    v_add_f32 v31, 1.0, v31
    v_rcp_f32 v24, v24
    v_rcp_f32 v25, v25
    v_rcp_f32 v26, v26
    v_rcp_f32 v27, v27
    v_rcp_f32 v28, v28
    v_rcp_f32 v29, v29
    v_rcp_f32 v30, v30
    v_rcp_f32 v31, v31
    v_mul_f32 v24, v24, v16
    v_mul_f32 v25, v25, v17
    v_mul_f32 v26, v26, v18
    v_mul_f32 v27, v27, v19
    v_mul_f32 v28, v28, v20
    v_mul_f32 v29, v29, v21
    v_mul_f32 v30, v30, v22
    v_mul_f32 v31, v31, v23
    v_cvt_pk_bf16_f32 v32, v24, v25
    v_cvt_pk_bf16_f32 v33, v26, v27
    v_cvt_pk_bf16_f32 v34, v28, v29
    v_cvt_pk_bf16_f32 v35, v30, v31
    buffer_store_dwordx4 v[32:35], v8, s[12:15], s35 offen sc1
m1_sync:
    s_lshl_b32 s31, s60, 17
    s_add_u32 s31, s31, 18612224
    s_lshl_b32 s49, s24, 11
    s_lshl_b32 s32, s25, 4
    s_add_u32 s49, s49, s32
    s_lshr_b32 s51, s2, 5
    s_mul_i32 s51, s51, 5
    s_lshr_b32 s51, s51, 2
    s_lshl_b32 s51, s51, 11
    s_and_b32 s32, s2, 3
    s_lshl_b32 s32, s32, 9
    s_add_u32 s51, s51, s32
    v_and_b32 v10, 31, v2
    v_lshlrev_b32 v10, 4, v10
    v_lshrrev_b32 v9, 5, v2
    v_lshl_add_u32 v10, v9, 11, v10
    s_add_u32 s49, s49, s31
    s_add_u32 s51, s51, s31
    v_lshlrev_b32 v9, 9, v2
    s_waitcnt vmcnt(0)
    s_barrier
    s_cmp_ge_u32 s2, 240
    s_cbranch_scc1 m1x_nosig
    s_cmp_lg_u32 s26, 0
    s_cbranch_scc1 m1x_nosig
    v_mov_b32 v4, 1
    s_mov_b64 exec, 0xf
    buffer_store_dword v4, v9, s[12:15], s49 offen sc0 sc1
    s_mov_b64 exec, -1
m1x_nosig:
    v_mov_b32 v240, v10
    s_mov_b32 s90, s51
    s_cmp_lt_u32 s26, 4
    s_cbranch_scc1 m2_compute
    s_branch m2_loader
m2_loader:
    s_and_b32 s24, s2, 7
    s_lshl_b32 s24, s24, 2
    s_lshr_b32 s25, s2, 3
    s_and_b32 s27, s25, 3
    s_add_u32 s24, s24, s27
    s_lshr_b32 s25, s25, 2
    v_lshlrev_b32 v3, 4, v2
    s_sub_u32 s26, s26, 4
    s_add_u32 s12, s8, 15728640
    s_addc_u32 s13, s9, 0
    s_mov_b32 s14, 1966080
    s_mov_b32 s15, 0x20000
    s_add_u32 s16, s8, 25165824
    s_addc_u32 s17, s9, 0
    s_mov_b32 s18, 6291456
    s_mov_b32 s19, 0x20000
    v_lshrrev_b32 v5, 3, v2
    v_lshlrev_b32 v5, 7, v5
    v_and_b32 v6, 7, v2
    v_lshrrev_b32 v7, 3, v2
    v_and_b32 v7, 2, v7
    v_xor_b32 v6, v6, v7
    v_lshl_add_u32 v8, v6, 4, v5
    v_xor_b32 v9, 64, v8
    s_mul_i32 s33, s25, 245760
    s_mul_i32 s34, s26, 12288
    s_add_u32 s33, s33, s34
    s_mul_i32 s34, s26, 49152
    s_mul_i32 s35, s24, 196608
    s_add_u32 s34, s34, s35
    s_mul_i32 s50, s26, 9216
    s_add_u32 s26, s26, 4
    s_mov_b32 s54, s50
    s_add_u32 s51, s50, 147456
m2_lw:
    s_add_u32 m0, s50, 5120
    s_add_u32 s35, s34, 0
    buffer_load_dwordx4 v8, s[16:19], s35 offen sc1 lds
    s_add_u32 m0, s50, 6144
    s_add_u32 s35, s34, 1024
    buffer_load_dwordx4 v9, s[16:19], s35 offen sc1 lds
    s_add_u32 m0, s50, 7168
    s_add_u32 s35, s34, 2048
    buffer_load_dwordx4 v8, s[16:19], s35 offen sc1 lds
    s_add_u32 m0, s50, 8192
    s_add_u32 s35, s34, 3072
    buffer_load_dwordx4 v9, s[16:19], s35 offen sc1 lds
    s_add_u32 s34, s34, 4096
    s_add_u32 s50, s50, 36864
    s_cmp_lg_u32 s50, s51
    s_cbranch_scc1 m2_lw
    s_mov_b32 s50, s54
    s_mov_b32 s53, 0
    s_barrier
m2_la:
    s_add_u32 m0, s50, 0
    s_add_u32 s35, s33, 0
    buffer_load_dwordx4 v3, s[12:15], s35 offen sc1 lds
    s_add_u32 m0, s50, 1024
    s_add_u32 s35, s33, 49152
    buffer_load_dwordx4 v3, s[12:15], s35 offen sc1 lds
    s_add_u32 m0, s50, 2048
    s_add_u32 s35, s33, 98304
    buffer_load_dwordx4 v3, s[12:15], s35 offen sc1 lds
    s_add_u32 m0, s50, 3072
    s_add_u32 s35, s33, 147456
    buffer_load_dwordx4 v3, s[12:15], s35 offen sc1 lds
    s_add_u32 m0, s50, 4096
    s_add_u32 s35, s33, 196608
    buffer_load_dwordx4 v3, s[12:15], s35 offen sc1 lds
    s_add_u32 s33, s33, 1024
    s_add_u32 s50, s50, 36864
    s_add_u32 s53, s53, 1
    s_cmp_lg_u32 s53, 2
    s_cbranch_scc1 m2_lb
    s_waitcnt vmcnt(5)
    s_barrier
m2_lb:
    s_cmp_lt_u32 s53, 4
    s_cbranch_scc1 m2_la
    s_mov_b32 s50, s54
    s_mov_b32 s53, 1
    s_waitcnt vmcnt(10)
    s_branch m2_l2
m2_l1:
    s_waitcnt vmcnt(18)
    s_cmp_lg_u32 s53, 2
    s_cbranch_scc1 m2_l2
    s_waitcnt vmcnt(14)
m2_l2:
    s_barrier
    s_add_u32 m0, s50, 0
    s_add_u32 s35, s33, 0
    buffer_load_dwordx4 v3, s[12:15], s35 offen sc1 lds
    s_add_u32 m0, s50, 1024
    s_add_u32 s35, s33, 49152
    buffer_load_dwordx4 v3, s[12:15], s35 offen sc1 lds
    s_add_u32 m0, s50, 2048
    s_add_u32 s35, s33, 98304
    buffer_load_dwordx4 v3, s[12:15], s35 offen sc1 lds
    s_add_u32 m0, s50, 3072
    s_add_u32 s35, s33, 147456
    buffer_load_dwordx4 v3, s[12:15], s35 offen sc1 lds
    s_add_u32 m0, s50, 4096
    s_add_u32 s35, s33, 196608
    buffer_load_dwordx4 v3, s[12:15], s35 offen sc1 lds
    s_add_u32 m0, s50, 5120
    s_add_u32 s35, s34, 0
    buffer_load_dwordx4 v8, s[16:19], s35 offen sc1 lds
    s_add_u32 m0, s50, 6144
    s_add_u32 s35, s34, 1024
    buffer_load_dwordx4 v9, s[16:19], s35 offen sc1 lds
    s_add_u32 m0, s50, 7168
    s_add_u32 s35, s34, 2048
    buffer_load_dwordx4 v8, s[16:19], s35 offen sc1 lds
    s_add_u32 m0, s50, 8192
    s_add_u32 s35, s34, 3072
    buffer_load_dwordx4 v9, s[16:19], s35 offen sc1 lds
    s_add_u32 s33, s33, 1024
    s_add_u32 s34, s34, 4096
    s_add_u32 s50, s50, 36864
    s_cmp_eq_u32 s50, s51
    s_cselect_b32 s50, s54, s50
    s_add_u32 s53, s53, 1
    s_cmp_le_u32 s53, 8
    s_cbranch_scc1 m2_l1
    s_waitcnt vmcnt(18)
    s_barrier
    s_waitcnt vmcnt(9)
    s_barrier
    s_waitcnt vmcnt(0)
    s_barrier
    s_waitcnt vmcnt(0)
    s_barrier
    s_barrier
    s_cmp_lg_u32 s60, 0
    s_cbranch_scc1 m2_end
    s_barrier
    s_branch q1_loader
m2_compute:
    s_load_dwordx2 s[4:5], s[0:1], 64
    s_load_dwordx2 s[10:11], s[0:1], 56
    s_cmp_lg_u32 s60, 0
    s_movk_i32 s43, 128
    s_cselect_b32 s43, 1280, s43
    s_mov_b32 s48, 262144
    s_cselect_b32 s48, 128, s48
    s_movk_i32 s41, 128
    s_mov_b32 s42, 262144
    s_mov_b32 s40, 18808832
    s_waitcnt lgkmcnt(0)
    s_cbranch_scc1 m2_c1
    s_add_u32 s4, s8, 13107200
    s_addc_u32 s5, s9, 0
m2_c1:
    s_and_b32 s24, s2, 7
    s_lshl_b32 s24, s24, 2
    s_lshr_b32 s25, s2, 3
    s_and_b32 s27, s25, 3
    s_add_u32 s24, s24, s27
    s_lshr_b32 s25, s25, 2
    v_lshlrev_b32 v3, 4, v2
    s_add_u32 s20, s8, 10485760
    s_addc_u32 s21, s9, 0
    s_mov_b32 s22, 2621440
    s_mov_b32 s23, 0x20000
    s_mov_b32 s44, s4
    s_mov_b32 s45, s5
    s_mov_b32 s46, 2621440
    s_mov_b32 s47, 0x20000
    s_mov_b32 s56, s10
    s_mov_b32 s57, s11
    s_mov_b32 s58, 4096
    s_mov_b32 s59, 0x20000
    s_lshr_b32 s27, s26, 1
    s_and_b32 s28, s26, 1
    s_lshl_b32 s29, s28, 1
    s_add_u32 s29, s29, s27
    v_and_b32 v4, 15, v2
    v_lshrrev_b32 v5, 4, v2
    s_mul_i32 s32, s25, 80
    s_lshl_b32 s31, s24, 2
    s_add_u32 s31, s31, s29
    s_lshl_b32 s31, s31, 4
    s_mul_i32 s30, s31, s41
    s_mul_i32 s31, s31, s43
    v_mul_u32_u24 v6, s41, v4
    v_mul_u32_u24 v7, s43, v4
    v_lshl_add_u32 v8, v5, 3, s32
    v_add_u32 v8, 0, v8
    v_lshrrev_b32 v9, 6, v8
    v_and_b32 v8, 63, v8
    v_lshl_add_u32 v10, v8, 1, v6
    v_mad_u32_u24 v14, v9, s42, v10
    buffer_load_dwordx4 v[20:23], v14, s[20:23], s30 offen sc1
    v_lshl_add_u32 v10, v8, 1, v7
    v_mad_u32_u24 v17, v9, s48, v10
    v_lshl_add_u32 v8, v5, 3, s32
    v_add_u32 v8, 32, v8
    v_lshrrev_b32 v9, 6, v8
    v_and_b32 v8, 63, v8
    v_lshl_add_u32 v10, v8, 1, v6
    v_mad_u32_u24 v15, v9, s42, v10
    buffer_load_dwordx4 v[24:27], v15, s[20:23], s30 offen sc1
    v_lshl_add_u32 v10, v8, 1, v7
    v_mad_u32_u24 v18, v9, s48, v10
    v_lshl_add_u32 v8, v5, 2, s32
    v_add_u32 v8, 64, v8
    v_lshrrev_b32 v9, 6, v8
    v_and_b32 v8, 63, v8
    v_lshl_add_u32 v10, v8, 1, v6
    v_mad_u32_u24 v16, v9, s42, v10
    buffer_load_dwordx2 v[28:29], v16, s[20:23], s30 offen sc1
    v_lshl_add_u32 v10, v8, 1, v7
    v_mad_u32_u24 v19, v9, s48, v10
    s_mul_i32 s30, s27, 18432
    v_lshlrev_b32 v4, 1, v4
    s_lshl_b32 s35, s24, 7
    s_lshl_b32 s36, s29, 5
    s_add_u32 s35, s35, s36
    buffer_load_ushort v30, v4, s[56:59], s35 offen
    v_lshrrev_b32 v4, 4, v2
    v_and_b32 v5, 15, v2
    v_lshrrev_b32 v6, 2, v5
    v_lshl_add_u32 v6, v4, 3, v6
    v_lshlrev_b32 v6, 7, v6
    v_lshrrev_b32 v7, 3, v5
    v_and_b32 v4, 1, v4
    v_lshl_add_u32 v7, v4, 1, v7
    v_lshl_add_u32 v6, v7, 5, v6
    v_and_b32 v7, 3, v2
    v_lshl_add_u32 v6, v7, 3, v6
    v_xor_b32 v8, s36, v6
    v_xor_b32 v9, 32, v8
    v_add_u32 v8, s30, v8
    v_add_u32 v9, s30, v9
    v_add_u32 v10, s30, v3
    v_mov_b32 v11, v8
    v_mov_b32 v12, v9
    v_mov_b32 v13, v10
    v_mov_b32 v64, 0
    v_mov_b32 v65, 0
    v_mov_b32 v66, 0
    v_mov_b32 v67, 0
    v_mov_b32 v68, 0
    v_mov_b32 v69, 0
    v_mov_b32 v70, 0
    v_mov_b32 v71, 0
    v_mov_b32 v72, 0
    v_mov_b32 v73, 0
    v_mov_b32 v74, 0
    v_mov_b32 v75, 0
    v_mov_b32 v76, 0
    v_mov_b32 v77, 0
    v_mov_b32 v78, 0
    v_mov_b32 v79, 0
    v_mov_b32 v80, 0
    v_mov_b32 v81, 0
    v_mov_b32 v82, 0
    v_mov_b32 v83, 0
    v_mov_b32 v84, 0
    v_mov_b32 v85, 0
    v_mov_b32 v86, 0
    v_mov_b32 v87, 0
    v_mov_b32 v88, 0
    v_mov_b32 v89, 0
    v_mov_b32 v90, 0
    v_mov_b32 v91, 0
    v_mov_b32 v92, 0
    v_mov_b32 v93, 0
    v_mov_b32 v94, 0
    v_mov_b32 v95, 0
    v_mov_b32 v96, 0
    v_mov_b32 v97, 0
    v_mov_b32 v98, 0
    v_mov_b32 v99, 0
    v_mov_b32 v100, 0
    v_mov_b32 v101, 0
    v_mov_b32 v102, 0
    v_mov_b32 v103, 0
    s_cmp_lg_u32 s26, 1
    s_cbranch_scc1 m1x_np
    s_mov_b32 s92, 65536
    s_mov_b32 exec_lo, 0xffffff
    s_mov_b32 exec_hi, 0xffffff
m1x_pl:
    buffer_load_dword v244, v240, s[12:15], s90 offen sc1
    s_waitcnt vmcnt(0)
    v_cmp_eq_u32 vcc, 0, v244
    s_nop 1
    s_cmp_eq_u64 vcc, 0
    s_cbranch_scc1 m1x_px
    s_sub_u32 s92, s92, 1
    s_cmp_lg_u32 s92, 0
    s_cbranch_scc1 m1x_pl
m1x_px:
    s_mov_b64 exec, -1
m1x_np:
    s_barrier
    s_mov_b32 s50, 0
    s_mov_b32 s53, 12
    s_barrier
    ds_read_b64_tr_b16 v[104:105], v11 offset:5120
    ds_read_b64_tr_b16 v[106:107], v11 offset:5632
    ds_read_b64_tr_b16 v[108:109], v12 offset:5120
    ds_read_b64_tr_b16 v[110:111], v12 offset:5632
    ds_read_b128 v[112:115], v13 offset:0
    ds_read_b128 v[116:119], v13 offset:1024
    ds_read_b128 v[120:123], v13 offset:2048
    ds_read_b128 v[124:127], v13 offset:3072
    ds_read_b128 v[128:131], v13 offset:4096
    ds_read_b64_tr_b16 v[132:133], v11 offset:14336
    ds_read_b64_tr_b16 v[134:135], v11 offset:14848
    ds_read_b64_tr_b16 v[136:137], v12 offset:14336
    ds_read_b64_tr_b16 v[138:139], v12 offset:14848
    ds_read_b128 v[140:143], v13 offset:9216
    ds_read_b128 v[144:147], v13 offset:10240
    ds_read_b128 v[148:151], v13 offset:11264
    ds_read_b128 v[152:155], v13 offset:12288
    ds_read_b128 v[156:159], v13 offset:13312
m2_cl:
    s_add_u32 s50, s50, 36864
    s_cmp_eq_u32 s50, 147456
    s_cselect_b32 s50, 0, s50
    v_add_u32 v11, s50, v8
    v_add_u32 v12, s50, v9
    v_add_u32 v13, s50, v10
    s_waitcnt lgkmcnt(0)
    s_barrier
    v_mfma_f32_16x16x32_bf16 v[64:67], v[112:115], v[104:107], v[64:67]
    ds_read_b64_tr_b16 v[160:161], v11 offset:5120
    v_mfma_f32_16x16x32_bf16 v[68:71], v[112:115], v[108:111], v[68:71]
    ds_read_b64_tr_b16 v[162:163], v11 offset:5632
    v_mfma_f32_16x16x32_bf16 v[72:75], v[116:119], v[104:107], v[72:75]
    ds_read_b64_tr_b16 v[164:165], v12 offset:5120
    v_mfma_f32_16x16x32_bf16 v[76:79], v[116:119], v[108:111], v[76:79]
    ds_read_b64_tr_b16 v[166:167], v12 offset:5632
    v_mfma_f32_16x16x32_bf16 v[80:83], v[120:123], v[104:107], v[80:83]
    ds_read_b128 v[168:171], v13 offset:0
    v_mfma_f32_16x16x32_bf16 v[84:87], v[120:123], v[108:111], v[84:87]
    ds_read_b128 v[172:175], v13 offset:1024
    v_mfma_f32_16x16x32_bf16 v[88:91], v[124:127], v[104:107], v[88:91]
    ds_read_b128 v[176:179], v13 offset:2048
    v_mfma_f32_16x16x32_bf16 v[92:95], v[124:127], v[108:111], v[92:95]
    ds_read_b128 v[180:183], v13 offset:3072
    v_mfma_f32_16x16x32_bf16 v[96:99], v[128:131], v[104:107], v[96:99]
    ds_read_b128 v[184:187], v13 offset:4096
    v_mfma_f32_16x16x32_bf16 v[100:103], v[128:131], v[108:111], v[100:103]
    ds_read_b64_tr_b16 v[188:189], v11 offset:14336
    v_mfma_f32_16x16x32_bf16 v[64:67], v[140:143], v[132:135], v[64:67]
    ds_read_b64_tr_b16 v[190:191], v11 offset:14848
    v_mfma_f32_16x16x32_bf16 v[68:71], v[140:143], v[136:139], v[68:71]
    ds_read_b64_tr_b16 v[192:193], v12 offset:14336
    v_mfma_f32_16x16x32_bf16 v[72:75], v[144:147], v[132:135], v[72:75]
    ds_read_b64_tr_b16 v[194:195], v12 offset:14848
    v_mfma_f32_16x16x32_bf16 v[76:79], v[144:147], v[136:139], v[76:79]
    ds_read_b128 v[196:199], v13 offset:9216
    v_mfma_f32_16x16x32_bf16 v[80:83], v[148:151], v[132:135], v[80:83]
    ds_read_b128 v[200:203], v13 offset:10240
    v_mfma_f32_16x16x32_bf16 v[84:87], v[148:151], v[136:139], v[84:87]
    ds_read_b128 v[204:207], v13 offset:11264
    v_mfma_f32_16x16x32_bf16 v[88:91], v[152:155], v[132:135], v[88:91]
    ds_read_b128 v[208:211], v13 offset:12288
    v_mfma_f32_16x16x32_bf16 v[92:95], v[152:155], v[136:139], v[92:95]
    ds_read_b128 v[212:215], v13 offset:13312
    v_mfma_f32_16x16x32_bf16 v[96:99], v[156:159], v[132:135], v[96:99]
    v_mfma_f32_16x16x32_bf16 v[100:103], v[156:159], v[136:139], v[100:103]
    s_sub_u32 s53, s53, 1
    s_cmp_eq_u32 s53, 0
    s_add_u32 s50, s50, 36864
    s_cmp_eq_u32 s50, 147456
    s_cselect_b32 s50, 0, s50
    v_add_u32 v11, s50, v8
    v_add_u32 v12, s50, v9
    v_add_u32 v13, s50, v10
    s_waitcnt lgkmcnt(0)
    s_barrier
    v_mfma_f32_16x16x32_bf16 v[64:67], v[168:171], v[160:163], v[64:67]
    ds_read_b64_tr_b16 v[104:105], v11 offset:5120
    v_mfma_f32_16x16x32_bf16 v[68:71], v[168:171], v[164:167], v[68:71]
    ds_read_b64_tr_b16 v[106:107], v11 offset:5632
    v_mfma_f32_16x16x32_bf16 v[72:75], v[172:175], v[160:163], v[72:75]
    ds_read_b64_tr_b16 v[108:109], v12 offset:5120
    v_mfma_f32_16x16x32_bf16 v[76:79], v[172:175], v[164:167], v[76:79]
    ds_read_b64_tr_b16 v[110:111], v12 offset:5632
    v_mfma_f32_16x16x32_bf16 v[80:83], v[176:179], v[160:163], v[80:83]
    ds_read_b128 v[112:115], v13 offset:0
    v_mfma_f32_16x16x32_bf16 v[84:87], v[176:179], v[164:167], v[84:87]
    ds_read_b128 v[116:119], v13 offset:1024
    v_mfma_f32_16x16x32_bf16 v[88:91], v[180:183], v[160:163], v[88:91]
    ds_read_b128 v[120:123], v13 offset:2048
    v_mfma_f32_16x16x32_bf16 v[92:95], v[180:183], v[164:167], v[92:95]
    ds_read_b128 v[124:127], v13 offset:3072
    v_mfma_f32_16x16x32_bf16 v[96:99], v[184:187], v[160:163], v[96:99]
    ds_read_b128 v[128:131], v13 offset:4096
    v_mfma_f32_16x16x32_bf16 v[100:103], v[184:187], v[164:167], v[100:103]
    ds_read_b64_tr_b16 v[132:133], v11 offset:14336
    v_mfma_f32_16x16x32_bf16 v[64:67], v[196:199], v[188:191], v[64:67]
    ds_read_b64_tr_b16 v[134:135], v11 offset:14848
    v_mfma_f32_16x16x32_bf16 v[68:71], v[196:199], v[192:195], v[68:71]
    ds_read_b64_tr_b16 v[136:137], v12 offset:14336
    v_mfma_f32_16x16x32_bf16 v[72:75], v[200:203], v[188:191], v[72:75]
    ds_read_b64_tr_b16 v[138:139], v12 offset:14848
    v_mfma_f32_16x16x32_bf16 v[76:79], v[200:203], v[192:195], v[76:79]
    ds_read_b128 v[140:143], v13 offset:9216
    v_mfma_f32_16x16x32_bf16 v[80:83], v[204:207], v[188:191], v[80:83]
    ds_read_b128 v[144:147], v13 offset:10240
    v_mfma_f32_16x16x32_bf16 v[84:87], v[204:207], v[192:195], v[84:87]
    ds_read_b128 v[148:151], v13 offset:11264
    v_mfma_f32_16x16x32_bf16 v[88:91], v[208:211], v[188:191], v[88:91]
    ds_read_b128 v[152:155], v13 offset:12288
    v_mfma_f32_16x16x32_bf16 v[92:95], v[208:211], v[192:195], v[92:95]
    ds_read_b128 v[156:159], v13 offset:13312
    v_mfma_f32_16x16x32_bf16 v[96:99], v[212:215], v[188:191], v[96:99]
    v_mfma_f32_16x16x32_bf16 v[100:103], v[212:215], v[192:195], v[100:103]
    s_sub_u32 s53, s53, 1
    s_cmp_eq_u32 s53, 0
    s_cbranch_scc0 m2_cl
m2_cx:
    s_waitcnt lgkmcnt(0)
    s_mul_i32 s30, s26, 5120
    v_add_u32 v4, s30, v3
    s_xor_b32 s30, s26, 2
    s_mul_i32 s30, s30, 5120
    v_add_u32 v5, s30, v3
    ds_write_b128 v4, v[68:71] offset:0
    ds_write_b128 v4, v[76:79] offset:1024
    ds_write_b128 v4, v[84:87] offset:2048
    ds_write_b128 v4, v[92:95] offset:3072
    ds_write_b128 v4, v[100:103] offset:4096
    s_waitcnt vmcnt(0)
    v_lshlrev_b32 v32, 16, v20
    v_and_b32 v33, 0xffff0000, v20
    v_lshlrev_b32 v34, 16, v21
    v_and_b32 v35, 0xffff0000, v21
    v_lshlrev_b32 v36, 16, v22
    v_and_b32 v37, 0xffff0000, v22
    v_lshlrev_b32 v38, 16, v23
    v_and_b32 v39, 0xffff0000, v23
    v_lshlrev_b32 v40, 16, v24
    v_and_b32 v41, 0xffff0000, v24
    v_lshlrev_b32 v42, 16, v25
    v_and_b32 v43, 0xffff0000, v25
    v_lshlrev_b32 v44, 16, v26
    v_and_b32 v45, 0xffff0000, v26
    v_lshlrev_b32 v46, 16, v27
    v_and_b32 v47, 0xffff0000, v27
    v_lshlrev_b32 v48, 16, v28
    v_and_b32 v49, 0xffff0000, v28
    v_lshlrev_b32 v50, 16, v29
    v_and_b32 v51, 0xffff0000, v29
    s_waitcnt lgkmcnt(0)
    s_barrier
    ds_read_b128 v[68:71], v5 offset:0
    ds_read_b128 v[76:79], v5 offset:1024
    ds_read_b128 v[84:87], v5 offset:2048
    ds_read_b128 v[92:95], v5 offset:3072
    ds_read_b128 v[100:103], v5 offset:4096
    v_lshlrev_b32 v30, 16, v30
    v_pk_add_f32 v[32:33], v[30:31], v[32:33] op_sel_hi:[0,1]
    v_pk_add_f32 v[34:35], v[30:31], v[34:35] op_sel_hi:[0,1]
    v_pk_add_f32 v[36:37], v[30:31], v[36:37] op_sel_hi:[0,1]
    v_pk_add_f32 v[38:39], v[30:31], v[38:39] op_sel_hi:[0,1]
    v_pk_add_f32 v[40:41], v[30:31], v[40:41] op_sel_hi:[0,1]
    v_pk_add_f32 v[42:43], v[30:31], v[42:43] op_sel_hi:[0,1]
    v_pk_add_f32 v[44:45], v[30:31], v[44:45] op_sel_hi:[0,1]
    v_pk_add_f32 v[46:47], v[30:31], v[46:47] op_sel_hi:[0,1]
    v_pk_add_f32 v[48:49], v[30:31], v[48:49] op_sel_hi:[0,1]
    v_pk_add_f32 v[50:51], v[30:31], v[50:51] op_sel_hi:[0,1]
    v_pk_add_f32 v[32:33], v[64:65], v[32:33]
    v_pk_add_f32 v[34:35], v[66:67], v[34:35]
    v_pk_add_f32 v[36:37], v[72:73], v[36:37]
    v_pk_add_f32 v[38:39], v[74:75], v[38:39]
    v_pk_add_f32 v[40:41], v[80:81], v[40:41]
    v_pk_add_f32 v[42:43], v[82:83], v[42:43]
    v_pk_add_f32 v[44:45], v[88:89], v[44:45]
    v_pk_add_f32 v[46:47], v[90:91], v[46:47]
    v_pk_add_f32 v[48:49], v[96:97], v[48:49]
    v_pk_add_f32 v[50:51], v[98:99], v[50:51]
    s_waitcnt lgkmcnt(3)
    v_pk_add_f32 v[32:33], v[68:69], v[32:33]
    v_pk_add_f32 v[34:35], v[70:71], v[34:35]
    v_pk_add_f32 v[36:37], v[76:77], v[36:37]
    v_pk_add_f32 v[38:39], v[78:79], v[38:39]
    v_cvt_pk_bf16_f32 v20, v32, v33
    v_cvt_pk_bf16_f32 v21, v34, v35
    v_cvt_pk_bf16_f32 v22, v36, v37
    v_cvt_pk_bf16_f32 v23, v38, v39
    s_cmp_lg_u32 s60, 0
    s_cbranch_scc1 m2_o0
    buffer_store_dwordx4 v[20:23], v17, s[44:47], s31 offen sc1
    s_branch m2_p0
m2_o0:
    buffer_store_dwordx4 v[20:23], v17, s[44:47], s31 offen
m2_p0:
    s_waitcnt lgkmcnt(1)
    v_pk_add_f32 v[40:41], v[84:85], v[40:41]
    v_pk_add_f32 v[42:43], v[86:87], v[42:43]
    v_pk_add_f32 v[44:45], v[92:93], v[44:45]
    v_pk_add_f32 v[46:47], v[94:95], v[46:47]
    v_cvt_pk_bf16_f32 v24, v40, v41
    v_cvt_pk_bf16_f32 v25, v42, v43
    v_cvt_pk_bf16_f32 v26, v44, v45
    v_cvt_pk_bf16_f32 v27, v46, v47
    s_cmp_lg_u32 s60, 0
    s_cbranch_scc1 m2_o1
    buffer_store_dwordx4 v[24:27], v18, s[44:47], s31 offen sc1
    s_branch m2_p1
m2_o1:
    buffer_store_dwordx4 v[24:27], v18, s[44:47], s31 offen
m2_p1:
    s_waitcnt lgkmcnt(0)
    v_pk_add_f32 v[48:49], v[100:101], v[48:49]
    v_pk_add_f32 v[50:51], v[102:103], v[50:51]
    v_cvt_pk_bf16_f32 v28, v48, v49
    v_cvt_pk_bf16_f32 v29, v50, v51
    s_cmp_lg_u32 s60, 0
    s_cbranch_scc1 m2_o2
    buffer_store_dwordx2 v[28:29], v19, s[44:47], s31 offen sc1
    s_branch m2_p2
m2_o2:
    buffer_store_dwordx2 v[28:29], v19, s[44:47], s31 offen
m2_p2:
    s_cmp_lg_u32 s60, 0
    s_cbranch_scc1 m2_fin
    v_mov_b32 v8, 0
    v_mov_b32 v9, 0
    s_mov_b32 s36, 0x3f803f80
    v_dot2c_f32_bf16 v8, s36, v20
    v_dot2c_f32_bf16 v9, v20, v20
    v_dot2c_f32_bf16 v8, s36, v21
    v_dot2c_f32_bf16 v9, v21, v21
    v_dot2c_f32_bf16 v8, s36, v22
    v_dot2c_f32_bf16 v9, v22, v22
    v_dot2c_f32_bf16 v8, s36, v23
    v_dot2c_f32_bf16 v9, v23, v23
    v_dot2c_f32_bf16 v8, s36, v24
    v_dot2c_f32_bf16 v9, v24, v24
    v_dot2c_f32_bf16 v8, s36, v25
    v_dot2c_f32_bf16 v9, v25, v25
    v_dot2c_f32_bf16 v8, s36, v26
    v_dot2c_f32_bf16 v9, v26, v26
    v_dot2c_f32_bf16 v8, s36, v27
    v_dot2c_f32_bf16 v9, v27, v27
    v_dot2c_f32_bf16 v8, s36, v28
    v_dot2c_f32_bf16 v9, v28, v28
    v_dot2c_f32_bf16 v8, s36, v29
    v_dot2c_f32_bf16 v9, v29, v29
    s_nop 1
    v_mov_b32 v10, v8
    v_mov_b32 v11, v9
    s_nop 0
    v_permlane32_swap_b32 v8, v10
    v_permlane32_swap_b32 v9, v11
    v_add_f32 v8, v8, v10
    v_add_f32 v9, v9, v11
    v_mov_b32 v10, v8
    v_mov_b32 v11, v9
    s_nop 0
    v_permlane16_swap_b32 v8, v10
    v_permlane16_swap_b32 v9, v11
    v_add_f32 v8, v8, v10
    v_add_f32 v9, v9, v11
    v_cmp_gt_u32 vcc, 16, v2
    v_and_b32 v10, 15, v2
    v_lshlrev_b32 v10, 3, v10
    v_lshrrev_b32 v11, 4, v2
    v_lshl_add_u32 v10, v11, 2, v10
    v_cndmask_b32 v8, v9, v8, vcc
    s_lshl_b32 s32, s24, 9
    s_lshl_b32 s33, s29, 7
    s_add_u32 s32, s32, s33
    s_add_u32 s32, s32, s40
    s_mov_b32 exec_hi, 0
    buffer_atomic_add_f32 v8, v10, s[12:15], s32 offen sc1
    s_mov_b64 exec, -1
    s_lshl_b32 s31, s60, 17
    s_add_u32 s31, s31, 18644992
    s_and_b32 s49, s2, 7
    s_lshl_b32 s49, s49, 2
    s_bfe_u32 s32, s2, 0x20003
    s_add_u32 s49, s49, s32
    s_and_b32 s51, s49, 1
    s_lshl_b32 s51, s51, 8
    s_lshr_b32 s49, s49, 1
    s_lshl_b32 s49, s49, 11
    s_add_u32 s49, s49, s51
    s_lshr_b32 s51, s2, 5
    s_lshl_b32 s51, s51, 5
    s_add_u32 s49, s49, s51
    s_bfe_u32 s51, s2, 0x20001
    s_lshl_b32 s51, s51, 2
    s_add_u32 s51, s51, s32
    s_lshl_b32 s51, s51, 11
    s_bfe_u32 s32, s2, 0x20005
    s_lshl_b32 s32, s32, 9
    s_add_u32 s51, s51, s32
    v_lshlrev_b32 v10, 5, v2
    s_add_u32 s49, s49, s31
    s_add_u32 s51, s51, s31
    v_lshlrev_b32 v9, 9, v2
    s_waitcnt vmcnt(0)
    s_barrier
    s_cmp_lg_u32 s26, 0
    s_cbranch_scc1 m2x_nosig
    v_mov_b32 v4, 1
    s_mov_b64 exec, 0xf
    buffer_store_dword v4, v9, s[12:15], s49 offen sc0 sc1
    s_mov_b64 exec, -1
m2x_nosig:
    v_mov_b32 v240, v10
    s_mov_b32 s90, s51
    s_branch q1_compute
m2_fin:
m2_end:
    s_endpgm
q1_loader:
q1_compute:
    s_load_dwordx2 s[6:7], s[0:1], 8
    s_add_u32 s4, s8, 13107200
    s_addc_u32 s5, s9, 0
    s_movk_i32 s41, 128
    s_mov_b32 s42, 262144
    s_mov_b32 s60, 1
    s_and_b32 s29, s2, 7
    s_lshr_b32 s30, s2, 3
    s_lshr_b32 s24, s29, 1
    s_lshl_b32 s24, s24, 2
    s_and_b32 s31, s30, 3
    s_add_u32 s24, s24, s31
    s_and_b32 s25, s29, 1
    s_lshl_b32 s25, s25, 3
    s_lshr_b32 s31, s30, 2
    s_add_u32 s25, s25, s31
    s_waitcnt lgkmcnt(0)
    s_mov_b32 s44, s4
    s_mov_b32 s45, s5
    s_mov_b32 s46, 2621440
    s_mov_b32 s47, 0x20000
    s_mov_b32 s16, s6
    s_mov_b32 s17, s7
    s_mov_b32 s18, 2457600
    s_mov_b32 s19, 0x20000
    s_mov_b32 s20, s8
    s_mov_b32 s21, s9
    s_mov_b32 s22, 18833408
    s_mov_b32 s23, 0x20000
    s_cmp_ge_u32 s25, 15
    s_cbranch_scc1 q1_repack
    s_cmp_lt_u32 s26, 4
    s_cbranch_scc1 q1_cmp
    s_sub_u32 s26, s26, 4
    v_lshrrev_b32 v7, 3, v2
    s_lshl_b32 s31, s24, 7
    s_lshl_b32 s32, s26, 5
    s_add_u32 s31, s31, s32
    v_add_u32 v7, s31, v7
    v_mul_u32_u24 v7, s41, v7
    s_lshl_b32 s41, s41, 3
    s_lshl_b32 s43, s41, 1
    s_add_u32 s48, s43, s41
    v_and_b32 v8, 7, v2
    v_lshrrev_b32 v9, 4, v2
    v_xor_b32 v8, v8, v9
    v_lshl_add_u32 v4, v8, 4, v7
    v_xor_b32 v5, 64, v4
    s_lshl_b32 s31, s26, 4
    v_add_u32 v7, s31, v9
    v_mul_u32_u24 v7, 3840, v7
    v_and_b32 v8, 15, v2
    v_lshlrev_b32 v10, 2, v9
    v_xor_b32 v8, v8, v10
    v_lshl_add_u32 v6, v8, 4, v7
    s_lshl_b32 s50, s26, 12
    s_mov_b32 s33, 0
    s_lshl_b32 s34, s25, 8
    s_add_u32 s26, s26, 4
    s_mov_b32 s54, s50
    s_add_u32 s51, s50, 131072
q1_lw:
    s_add_u32 m0, s50, 16384
    s_add_u32 s35, s34, 0
    buffer_load_dwordx4 v6, s[16:19], s35 offen lds
    s_add_u32 m0, s50, 17408
    s_add_u32 s35, s34, 15360
    buffer_load_dwordx4 v6, s[16:19], s35 offen lds
    s_add_u32 m0, s50, 18432
    s_add_u32 s35, s34, 30720
    buffer_load_dwordx4 v6, s[16:19], s35 offen lds
    s_add_u32 m0, s50, 19456
    s_add_u32 s35, s34, 46080
    buffer_load_dwordx4 v6, s[16:19], s35 offen lds
    s_add_u32 s34, s34, 245760
    s_add_u32 s50, s50, 32768
    s_cmp_lg_u32 s50, s51
    s_cbranch_scc1 q1_lw
    s_mov_b32 s50, s54
    s_mov_b32 s53, 0
    s_barrier
q1_la:
    s_add_u32 m0, s50, 0
    s_add_u32 s35, s33, 0
    buffer_load_dwordx4 v4, s[44:47], s35 offen sc1 lds
    s_add_u32 m0, s50, 1024
    s_add_u32 s35, s33, s41
    buffer_load_dwordx4 v5, s[44:47], s35 offen sc1 lds
    s_add_u32 m0, s50, 2048
    s_add_u32 s35, s33, s43
    buffer_load_dwordx4 v4, s[44:47], s35 offen sc1 lds
    s_add_u32 m0, s50, 3072
    s_add_u32 s35, s33, s48
    buffer_load_dwordx4 v5, s[44:47], s35 offen sc1 lds
    s_add_u32 s33, s33, s42
    s_add_u32 s50, s50, 32768
    s_add_u32 s53, s53, 1
    s_cmp_lg_u32 s53, 2
    s_cbranch_scc1 q1_lb
    s_waitcnt vmcnt(4)
    s_barrier
q1_lb:
    s_cmp_lt_u32 s53, 4
    s_cbranch_scc1 q1_la
    s_mov_b32 s50, s54
    s_mov_b32 s53, 1
    s_waitcnt vmcnt(8)
    s_branch q1_l2
q1_l1:
    s_waitcnt vmcnt(16)
    s_cmp_lg_u32 s53, 2
    s_cbranch_scc1 q1_l2
    s_waitcnt vmcnt(12)
q1_l2:
    s_barrier
    s_add_u32 m0, s50, 0
    s_add_u32 s35, s33, 0
    buffer_load_dwordx4 v4, s[44:47], s35 offen sc1 lds
    s_add_u32 m0, s50, 1024
    s_add_u32 s35, s33, s41
    buffer_load_dwordx4 v5, s[44:47], s35 offen sc1 lds
    s_add_u32 m0, s50, 2048
    s_add_u32 s35, s33, s43
    buffer_load_dwordx4 v4, s[44:47], s35 offen sc1 lds
    s_add_u32 m0, s50, 3072
    s_add_u32 s35, s33, s48
    buffer_load_dwordx4 v5, s[44:47], s35 offen sc1 lds
    s_add_u32 m0, s50, 16384
    s_add_u32 s35, s34, 0
    buffer_load_dwordx4 v6, s[16:19], s35 offen lds
    s_add_u32 m0, s50, 17408
    s_add_u32 s35, s34, 15360
    buffer_load_dwordx4 v6, s[16:19], s35 offen lds
    s_add_u32 m0, s50, 18432
    s_add_u32 s35, s34, 30720
    buffer_load_dwordx4 v6, s[16:19], s35 offen lds
    s_add_u32 m0, s50, 19456
    s_add_u32 s35, s34, 46080
    buffer_load_dwordx4 v6, s[16:19], s35 offen lds
    s_add_u32 s33, s33, s42
    s_add_u32 s34, s34, 245760
    s_add_u32 s50, s50, 32768
    s_cmp_eq_u32 s50, s51
    s_cselect_b32 s50, s54, s50
    s_add_u32 s53, s53, 1
    s_cmp_le_u32 s53, 6
    s_cbranch_scc1 q1_l1
    s_waitcnt vmcnt(16)
    s_barrier
    s_waitcnt vmcnt(8)
    s_barrier
    s_waitcnt vmcnt(0)
    s_barrier
    s_waitcnt vmcnt(0)
    s_barrier
    s_barrier
    s_barrier
    s_branch att_l1
q1_cmp:
    s_lshr_b32 s27, s26, 1
    s_and_b32 s28, s26, 1
    v_and_b32 v18, 31, v2
    v_lshrrev_b32 v19, 5, v2
    v_lshrrev_b32 v20, 1, v18
    v_and_b32 v20, 7, v20
    v_xor_b32 v20, v20, v19
    v_lshlrev_b32 v20, 4, v20
    v_lshl_add_u32 v20, v18, 7, v20
    s_lshl_b32 s31, s27, 13
    s_lshl_b32 s32, s28, 12
    s_add_u32 s31, s31, s32
    v_add_u32 v8, s31, v20
    v_xor_b32 v12, 0x1000, v8
    v_xor_b32 v9, 32, v8
    v_xor_b32 v13, 32, v12
    v_xor_b32 v10, 64, v8
    v_xor_b32 v14, 64, v12
    v_xor_b32 v11, 96, v8
    v_xor_b32 v15, 96, v12
    v_and_b32 v20, 15, v2
    v_lshrrev_b32 v21, 2, v20
    v_lshl_add_u32 v22, v19, 3, v21
    v_lshlrev_b32 v22, 8, v22
    s_lshl_b32 s31, s28, 1
    s_add_u32 s31, s31, s27
    v_xor_b32 v21, s31, v21
    v_lshl_add_u32 v22, v21, 6, v22
    v_and_b32 v21, 16, v2
    v_lshl_add_u32 v22, v21, 1, v22
    v_and_b32 v21, 3, v2
    v_lshl_add_u32 v22, v21, 3, v22
    v_add_u32 v16, 16384, v22
    v_xor_b32 v17, 64, v16
    v_mov_b32 v25, 0
    v_lshrrev_b32 v20, 2, v2
    v_lshrrev_b32 v21, 4, v2
    v_xor_b32 v20, v20, v21
    v_and_b32 v20, 1, v20
    v_cmp_eq_u32 vcc, 0, v20
    v_mov_b32 v21, 0x3f803f80
    s_nop 0
    v_cndmask_b32 v140, 0, v21, vcc
    v_cndmask_b32 v141, 0, v21, vcc
    v_cndmask_b32 v142, 0, v21, vcc
    v_cndmask_b32 v143, 0, v21, vcc
    s_mov_b32 s36, 0xffff0000
    v_mov_b32 v144, 0
    v_mov_b32 v145, 0
    v_mov_b32 v146, 0
    v_mov_b32 v147, 0
    v_mov_b32 v148, 0
    v_mov_b32 v149, 0
    v_mov_b32 v150, 0
    v_mov_b32 v151, 0
    v_mov_b32 v64, 0
    v_mov_b32 v65, 0
    v_mov_b32 v66, 0
    v_mov_b32 v67, 0
    v_mov_b32 v68, 0
    v_mov_b32 v69, 0
    v_mov_b32 v70, 0
    v_mov_b32 v71, 0
    v_mov_b32 v72, 0
    v_mov_b32 v73, 0
    v_mov_b32 v74, 0
    v_mov_b32 v75, 0
    v_mov_b32 v76, 0
    v_mov_b32 v77, 0
    v_mov_b32 v78, 0
    v_mov_b32 v79, 0
    v_mov_b32 v80, 0
    v_mov_b32 v81, 0
    v_mov_b32 v82, 0
    v_mov_b32 v83, 0
    v_mov_b32 v84, 0
    v_mov_b32 v85, 0
    v_mov_b32 v86, 0
    v_mov_b32 v87, 0
    v_mov_b32 v88, 0
    v_mov_b32 v89, 0
    v_mov_b32 v90, 0
    v_mov_b32 v91, 0
    v_mov_b32 v92, 0
    v_mov_b32 v93, 0
    v_mov_b32 v94, 0
    v_mov_b32 v95, 0
    v_mov_b32 v96, 0
    v_mov_b32 v97, 0
    v_mov_b32 v98, 0
    v_mov_b32 v99, 0
    v_mov_b32 v100, 0
    v_mov_b32 v101, 0
    v_mov_b32 v102, 0
    v_mov_b32 v103, 0
    v_mov_b32 v104, 0
    v_mov_b32 v105, 0
    v_mov_b32 v106, 0
    v_mov_b32 v107, 0
    v_mov_b32 v108, 0
    v_mov_b32 v109, 0
    v_mov_b32 v110, 0
    v_mov_b32 v111, 0
    v_mov_b32 v112, 0
    v_mov_b32 v113, 0
    v_mov_b32 v114, 0
    v_mov_b32 v115, 0
    v_mov_b32 v116, 0
    v_mov_b32 v117, 0
    v_mov_b32 v118, 0
    v_mov_b32 v119, 0
    v_mov_b32 v120, 0
    v_mov_b32 v121, 0
    v_mov_b32 v122, 0
    v_mov_b32 v123, 0
    v_mov_b32 v124, 0
    v_mov_b32 v125, 0
    v_mov_b32 v126, 0
    v_mov_b32 v127, 0
    v_mov_b32 v128, v8
    v_mov_b32 v129, v9
    v_mov_b32 v130, v10
    v_mov_b32 v131, v11
    v_mov_b32 v132, v12
    v_mov_b32 v133, v13
    v_mov_b32 v134, v14
    v_mov_b32 v135, v15
    v_mov_b32 v136, v16
    v_mov_b32 v137, v17
    s_lshr_b32 s38, s24, 1
    s_and_b32 s39, s24, 1
    s_lshl_b32 s39, s39, 2
    s_lshl_b32 s31, s27, 1
    s_add_u32 s39, s39, s31
    s_cmp_lt_u32 s25, 5
    s_mov_b32 s41, 163840
    s_cselect_b32 s41, 81920, s41
    s_movk_i32 s42, 20480
    s_cselect_b32 s42, 10240, s42
    s_cselect_b32 s43, 0, 2621440
    s_cselect_b32 s44, 0, 5
    s_sub_u32 s44, s25, s44
    s_mul_i32 s42, s42, s38
    s_add_u32 s43, s43, s42
    s_add_u32 s39, s39, s28
    s_xor_b32 s45, s39, 1
    s_lshl_b32 s31, s44, 5
    s_lshl_b32 s32, s28, 4
    s_add_u32 s31, s31, s32
    s_lshl_b32 s32, s27, 3
    s_add_u32 s46, s31, s32
    s_xor_b32 s47, s46, 8
    s_movk_i32 s48, 1024
    v_lshlrev_b32 v48, 3, v18
    v_lshlrev_b32 v49, 3, v18
    v_add_u32 v49, 8192, v49
    v_add_u32 v40, s46, v19
    v_add_u32 v40, 0, v40
    v_mul_u32_u24 v41, 52429, v40
    v_lshrrev_b32 v41, 18, v41
    v_mul_u32_u24 v42, 5, v41
    v_sub_u32 v42, v40, v42
    v_mul_lo_u32 v41, v41, s41
    v_lshrrev_b32 v43, 1, v42
    v_lshl_add_u32 v43, v43, 8, v48
    v_and_b32 v44, 1, v42
    v_lshl_add_u32 v43, v44, 9, v43
    v_cmp_gt_u32 vcc, 4, v42
    v_mov_b32 v45, 256
    v_mov_b32 v46, s48
    v_cndmask_b32 v43, v49, v43, vcc
    v_cndmask_b32 v45, v45, v46, vcc
    v_add_u32 v41, v41, v43
    v_mad_u32_u24 v152, v45, s39, v41
    v_mad_u32_u24 v153, v45, s45, v41
    v_add_u32 v40, s46, v19
    v_add_u32 v40, 2, v40
    v_mul_u32_u24 v41, 52429, v40
    v_lshrrev_b32 v41, 18, v41
    v_mul_u32_u24 v42, 5, v41
    v_sub_u32 v42, v40, v42
    v_mul_lo_u32 v41, v41, s41
    v_lshrrev_b32 v43, 1, v42
    v_lshl_add_u32 v43, v43, 8, v48
    v_and_b32 v44, 1, v42
    v_lshl_add_u32 v43, v44, 9, v43
    v_cmp_gt_u32 vcc, 4, v42
    v_mov_b32 v45, 256
    v_mov_b32 v46, s48
    v_cndmask_b32 v43, v49, v43, vcc
    v_cndmask_b32 v45, v45, v46, vcc
    v_add_u32 v41, v41, v43
    v_mad_u32_u24 v154, v45, s39, v41
    v_mad_u32_u24 v155, v45, s45, v41
    v_add_u32 v40, s46, v19
    v_add_u32 v40, 4, v40
    v_mul_u32_u24 v41, 52429, v40
    v_lshrrev_b32 v41, 18, v41
    v_mul_u32_u24 v42, 5, v41
    v_sub_u32 v42, v40, v42
    v_mul_lo_u32 v41, v41, s41
    v_lshrrev_b32 v43, 1, v42
    v_lshl_add_u32 v43, v43, 8, v48
    v_and_b32 v44, 1, v42
    v_lshl_add_u32 v43, v44, 9, v43
    v_cmp_gt_u32 vcc, 4, v42
    v_mov_b32 v45, 256
    v_mov_b32 v46, s48
    v_cndmask_b32 v43, v49, v43, vcc
    v_cndmask_b32 v45, v45, v46, vcc
    v_add_u32 v41, v41, v43
    v_mad_u32_u24 v156, v45, s39, v41
    v_mad_u32_u24 v157, v45, s45, v41
    v_add_u32 v40, s46, v19
    v_add_u32 v40, 6, v40
    v_mul_u32_u24 v41, 52429, v40
    v_lshrrev_b32 v41, 18, v41
    v_mul_u32_u24 v42, 5, v41
    v_sub_u32 v42, v40, v42
    v_mul_lo_u32 v41, v41, s41
    v_lshrrev_b32 v43, 1, v42
    v_lshl_add_u32 v43, v43, 8, v48
    v_and_b32 v44, 1, v42
    v_lshl_add_u32 v43, v44, 9, v43
    v_cmp_gt_u32 vcc, 4, v42
    v_mov_b32 v45, 256
    v_mov_b32 v46, s48
    v_cndmask_b32 v43, v49, v43, vcc
    v_cndmask_b32 v45, v45, v46, vcc
    v_add_u32 v41, v41, v43
    v_mad_u32_u24 v158, v45, s39, v41
    v_mad_u32_u24 v159, v45, s45, v41
    v_add_u32 v40, s47, v19
    v_add_u32 v40, 0, v40
    v_mul_u32_u24 v41, 52429, v40
    v_lshrrev_b32 v41, 18, v41
    v_mul_u32_u24 v42, 5, v41
    v_sub_u32 v42, v40, v42
    v_mul_lo_u32 v41, v41, s41
    v_lshrrev_b32 v43, 1, v42
    v_lshl_add_u32 v43, v43, 8, v48
    v_and_b32 v44, 1, v42
    v_lshl_add_u32 v43, v44, 9, v43
    v_cmp_gt_u32 vcc, 4, v42
    v_mov_b32 v45, 256
    v_mov_b32 v46, s48
    v_cndmask_b32 v43, v49, v43, vcc
    v_cndmask_b32 v45, v45, v46, vcc
    v_add_u32 v41, v41, v43
    v_mad_u32_u24 v160, v45, s39, v41
    v_mad_u32_u24 v161, v45, s45, v41
    v_add_u32 v40, s47, v19
    v_add_u32 v40, 2, v40
    v_mul_u32_u24 v41, 52429, v40
    v_lshrrev_b32 v41, 18, v41
    v_mul_u32_u24 v42, 5, v41
    v_sub_u32 v42, v40, v42
    v_mul_lo_u32 v41, v41, s41
    v_lshrrev_b32 v43, 1, v42
    v_lshl_add_u32 v43, v43, 8, v48
    v_and_b32 v44, 1, v42
    v_lshl_add_u32 v43, v44, 9, v43
    v_cmp_gt_u32 vcc, 4, v42
    v_mov_b32 v45, 256
    v_mov_b32 v46, s48
    v_cndmask_b32 v43, v49, v43, vcc
    v_cndmask_b32 v45, v45, v46, vcc
    v_add_u32 v41, v41, v43
    v_mad_u32_u24 v162, v45, s39, v41
    v_mad_u32_u24 v163, v45, s45, v41
    v_add_u32 v40, s47, v19
    v_add_u32 v40, 4, v40
    v_mul_u32_u24 v41, 52429, v40
    v_lshrrev_b32 v41, 18, v41
    v_mul_u32_u24 v42, 5, v41
    v_sub_u32 v42, v40, v42
    v_mul_lo_u32 v41, v41, s41
    v_lshrrev_b32 v43, 1, v42
    v_lshl_add_u32 v43, v43, 8, v48
    v_and_b32 v44, 1, v42
    v_lshl_add_u32 v43, v44, 9, v43
    v_cmp_gt_u32 vcc, 4, v42
    v_mov_b32 v45, 256
    v_mov_b32 v46, s48
    v_cndmask_b32 v43, v49, v43, vcc
    v_cndmask_b32 v45, v45, v46, vcc
    v_add_u32 v41, v41, v43
    v_mad_u32_u24 v164, v45, s39, v41
    v_mad_u32_u24 v165, v45, s45, v41
    v_add_u32 v40, s47, v19
    v_add_u32 v40, 6, v40
    v_mul_u32_u24 v41, 52429, v40
    v_lshrrev_b32 v41, 18, v41
    v_mul_u32_u24 v42, 5, v41
    v_sub_u32 v42, v40, v42
    v_mul_lo_u32 v41, v41, s41
    v_lshrrev_b32 v43, 1, v42
    v_lshl_add_u32 v43, v43, 8, v48
    v_and_b32 v44, 1, v42
    v_lshl_add_u32 v43, v44, 9, v43
    v_cmp_gt_u32 vcc, 4, v42
    v_mov_b32 v45, 256
    v_mov_b32 v46, s48
    v_cndmask_b32 v43, v49, v43, vcc
    v_cndmask_b32 v45, v45, v46, vcc
    v_add_u32 v41, v41, v43
    v_mad_u32_u24 v166, v45, s39, v41
    v_mad_u32_u24 v167, v45, s45, v41
    s_lshl_b32 s31, s24, 7
    s_lshl_b32 s32, s26, 5
    s_add_u32 s31, s31, s32
    s_lshl_b32 s31, s31, 3
    s_add_u32 s31, s31, 18808832
    v_lshlrev_b32 v20, 3, v18
    s_lshl_b32 s32, s25, 7
    s_lshl_b32 s33, s28, 6
    s_add_u32 s32, s32, s33
    s_lshl_b32 s33, s27, 5
    s_add_u32 s32, s32, s33
    s_lshl_b32 s32, s32, 2
    s_add_u32 s32, s32, 18825216
    v_lshlrev_b32 v21, 2, v18
    buffer_load_dword v148, v21, s[20:23], s32 offen
    s_cmp_lg_u32 s26, 1
    s_cbranch_scc1 m2x_np
    s_mov_b32 s92, 65536
    s_mov_b32 exec_lo, 0xffff
    s_mov_b32 exec_hi, 0x0
m2x_pl:
    buffer_load_dword v244, v240, s[12:15], s90 offen sc1
    s_waitcnt vmcnt(0)
    v_cmp_eq_u32 vcc, 0, v244
    s_nop 1
    s_cmp_eq_u64 vcc, 0
    s_cbranch_scc1 m2x_px
    s_sub_u32 s92, s92, 1
    s_cmp_lg_u32 s92, 0
    s_cbranch_scc1 m2x_pl
m2x_px:
    s_mov_b64 exec, -1
m2x_np:
    s_barrier
    buffer_load_dwordx2 v[144:145], v20, s[20:23], s31 offen sc1
    s_mov_b32 s50, 0
    s_mov_b32 s53, 10
    s_barrier
    ds_read_b128 v[32:35], v8
    ds_read_b128 v[36:39], v12
    ds_read_b64_tr_b16 v[40:41], v16 offset:0
    ds_read_b64_tr_b16 v[42:43], v16 offset:1024
    ds_read_b64_tr_b16 v[44:45], v17 offset:0
    ds_read_b64_tr_b16 v[46:47], v17 offset:1024
    s_cmp_ge_u32 s25, 10
    s_cbranch_scc1 q1_vloop
q1_qkloop:
    s_add_u32 s50, s50, 0x8000
    s_and_b32 s50, s50, 0x1ffff
    s_waitcnt lgkmcnt(0)
    v_mfma_f32_32x32x16_bf16 v[64:79], v[40:43], v[32:35], v[64:79]
    ds_read_b128 v[48:51], v9
    ds_read_b128 v[52:55], v13
    ds_read_b64_tr_b16 v[56:57], v16 offset:4096
    v_mfma_f32_32x32x16_bf16 v[80:95], v[44:47], v[32:35], v[80:95]
    ds_read_b64_tr_b16 v[58:59], v16 offset:5120
    ds_read_b64_tr_b16 v[60:61], v17 offset:4096
    ds_read_b64_tr_b16 v[62:63], v17 offset:5120
    v_mfma_f32_32x32x16_bf16 v[96:111], v[40:43], v[36:39], v[96:111]
    v_mfma_f32_32x32x16_bf16 v[112:127], v[44:47], v[36:39], v[112:127]
    s_waitcnt lgkmcnt(0)
    v_mfma_f32_32x32x16_bf16 v[64:79], v[56:59], v[48:51], v[64:79]
    ds_read_b128 v[32:35], v10
    ds_read_b128 v[36:39], v14
    ds_read_b64_tr_b16 v[40:41], v16 offset:8192
    v_mfma_f32_32x32x16_bf16 v[80:95], v[60:63], v[48:51], v[80:95]
    ds_read_b64_tr_b16 v[42:43], v16 offset:9216
    ds_read_b64_tr_b16 v[44:45], v17 offset:8192
    ds_read_b64_tr_b16 v[46:47], v17 offset:9216
    v_mfma_f32_32x32x16_bf16 v[96:111], v[56:59], v[52:55], v[96:111]
    v_mfma_f32_32x32x16_bf16 v[112:127], v[60:63], v[52:55], v[112:127]
    s_waitcnt lgkmcnt(0)
    v_mfma_f32_32x32x16_bf16 v[64:79], v[40:43], v[32:35], v[64:79]
    ds_read_b128 v[48:51], v11
    ds_read_b128 v[52:55], v15
    ds_read_b64_tr_b16 v[56:57], v16 offset:12288
    v_mfma_f32_32x32x16_bf16 v[80:95], v[44:47], v[32:35], v[80:95]
    ds_read_b64_tr_b16 v[58:59], v16 offset:13312
    ds_read_b64_tr_b16 v[60:61], v17 offset:12288
    ds_read_b64_tr_b16 v[62:63], v17 offset:13312
    v_mfma_f32_32x32x16_bf16 v[96:111], v[40:43], v[36:39], v[96:111]
    v_mfma_f32_32x32x16_bf16 v[112:127], v[44:47], v[36:39], v[112:127]
    s_waitcnt lgkmcnt(0)
    v_mfma_f32_32x32x16_bf16 v[64:79], v[56:59], v[48:51], v[64:79]
    v_add_u32 v8, s50, v128
    v_add_u32 v9, s50, v129
    v_add_u32 v10, s50, v130
    v_add_u32 v11, s50, v131
    v_add_u32 v12, s50, v132
    v_mfma_f32_32x32x16_bf16 v[80:95], v[60:63], v[48:51], v[80:95]
    v_add_u32 v13, s50, v133
    v_add_u32 v14, s50, v134
    v_add_u32 v15, s50, v135
    v_add_u32 v16, s50, v136
    v_add_u32 v17, s50, v137
    s_barrier
    ds_read_b128 v[32:35], v8
    ds_read_b128 v[36:39], v12
    ds_read_b64_tr_b16 v[40:41], v16 offset:0
    v_mfma_f32_32x32x16_bf16 v[96:111], v[56:59], v[52:55], v[96:111]
    ds_read_b64_tr_b16 v[42:43], v16 offset:1024
    ds_read_b64_tr_b16 v[44:45], v17 offset:0
    ds_read_b64_tr_b16 v[46:47], v17 offset:1024
    v_mfma_f32_32x32x16_bf16 v[112:127], v[60:63], v[52:55], v[112:127]
    s_sub_u32 s53, s53, 1
    s_cmp_lg_u32 s53, 0
    s_cbranch_scc1 q1_qkloop
    s_waitcnt lgkmcnt(0)
    s_waitcnt vmcnt(0)
    v_mov_b32 v25, v145
    v_mov_b32 v26, v148
    v_mul_f32 v24, 0x3acccccd, v144
    s_waitcnt lgkmcnt(0)
    v_mul_f32 v25, 0x3acccccd, v25
    v_fma_f32 v25, -v24, v24, v25
    v_max_f32 v25, 0, v25
    v_add_f32 v25, 0x3727c5ac, v25
    v_rsq_f32 v25, v25
    s_cmp_lt_u32 s25, 5
    s_cselect_b32 s31, 0x3ea52b5c, 1.0
    v_mul_f32 v25, s31, v25
    v_mul_f32 v27, -v24, v25
    s_lshl_b32 s31, s27, 8
    s_lshl_b32 s32, s28, 7
    s_add_u32 s33, s31, s32
    s_add_u32 s33, s33, 0x20000
    v_lshl_add_u32 v28, v18, 2, s33
    ds_write_b32 v28, v25
    ds_write_b32 v28, v27 offset:512
    s_lshl_b32 s31, s28, 8
    s_lshl_b32 s32, s27, 7
    s_add_u32 s37, s31, s32
    s_add_u32 s37, s37, 0x20400
    v_lshl_add_u32 v29, v18, 2, s37
    ds_write_b32 v29, v26
    s_waitcnt lgkmcnt(0)
    s_barrier
    s_lshr_b32 s38, s24, 1
    s_and_b32 s39, s24, 1
    s_lshl_b32 s39, s39, 2
    s_lshl_b32 s31, s27, 1
    s_add_u32 s39, s39, s31
    v_xor_b32 v30, 128, v28
    ds_read_b32 v32, v28
    ds_read_b32 v33, v28 offset:512
    ds_read_b32 v34, v30
    ds_read_b32 v35, v30 offset:512
    v_lshl_add_u32 v31, v19, 4, s37
    v_xor_b32 v30, 128, v31
    ds_read_b128 v[36:39], v31 offset:0
    ds_read_b128 v[40:43], v31 offset:32
    ds_read_b128 v[44:47], v31 offset:64
    ds_read_b128 v[48:51], v31 offset:96
    ds_read_b128 v[128:131], v30 offset:0
    ds_read_b128 v[132:135], v30 offset:32
    ds_read_b128 v[136:139], v30 offset:64
    ds_read_b128 v[140:143], v30 offset:96
    s_waitcnt lgkmcnt(0)
    v_pk_mul_f32 v[64:65], v[32:33], v[64:65] op_sel_hi:[0,1]
    v_pk_mul_f32 v[66:67], v[32:33], v[66:67] op_sel_hi:[0,1]
    v_pk_fma_f32 v[64:65], v[32:33], v[36:37], v[64:65] op_sel:[1,0,0] op_sel_hi:[1,1,1]
    v_pk_fma_f32 v[66:67], v[32:33], v[38:39], v[66:67] op_sel:[1,0,0] op_sel_hi:[1,1,1]
    v_cvt_pk_bf16_f32 v64, v64, v65
    v_cvt_pk_bf16_f32 v65, v66, v67
    buffer_store_dwordx2 v[64:65], v152, s[20:23], s43 offen sc1
    v_pk_mul_f32 v[96:97], v[34:35], v[96:97] op_sel_hi:[0,1]
    v_pk_mul_f32 v[98:99], v[34:35], v[98:99] op_sel_hi:[0,1]
    v_pk_fma_f32 v[96:97], v[34:35], v[36:37], v[96:97] op_sel:[1,0,0] op_sel_hi:[1,1,1]
    v_pk_fma_f32 v[98:99], v[34:35], v[38:39], v[98:99] op_sel:[1,0,0] op_sel_hi:[1,1,1]
    v_cvt_pk_bf16_f32 v96, v96, v97
    v_cvt_pk_bf16_f32 v97, v98, v99
    buffer_store_dwordx2 v[96:97], v153, s[20:23], s43 offen sc1
    v_pk_mul_f32 v[68:69], v[32:33], v[68:69] op_sel_hi:[0,1]
    v_pk_mul_f32 v[70:71], v[32:33], v[70:71] op_sel_hi:[0,1]
    v_pk_fma_f32 v[68:69], v[32:33], v[40:41], v[68:69] op_sel:[1,0,0] op_sel_hi:[1,1,1]
    v_pk_fma_f32 v[70:71], v[32:33], v[42:43], v[70:71] op_sel:[1,0,0] op_sel_hi:[1,1,1]
    v_cvt_pk_bf16_f32 v68, v68, v69
    v_cvt_pk_bf16_f32 v69, v70, v71
    buffer_store_dwordx2 v[68:69], v154, s[20:23], s43 offen sc1
    v_pk_mul_f32 v[100:101], v[34:35], v[100:101] op_sel_hi:[0,1]
    v_pk_mul_f32 v[102:103], v[34:35], v[102:103] op_sel_hi:[0,1]
    v_pk_fma_f32 v[100:101], v[34:35], v[40:41], v[100:101] op_sel:[1,0,0] op_sel_hi:[1,1,1]
    v_pk_fma_f32 v[102:103], v[34:35], v[42:43], v[102:103] op_sel:[1,0,0] op_sel_hi:[1,1,1]
    v_cvt_pk_bf16_f32 v100, v100, v101
    v_cvt_pk_bf16_f32 v101, v102, v103
    buffer_store_dwordx2 v[100:101], v155, s[20:23], s43 offen sc1
    v_pk_mul_f32 v[72:73], v[32:33], v[72:73] op_sel_hi:[0,1]
    v_pk_mul_f32 v[74:75], v[32:33], v[74:75] op_sel_hi:[0,1]
    v_pk_fma_f32 v[72:73], v[32:33], v[44:45], v[72:73] op_sel:[1,0,0] op_sel_hi:[1,1,1]
    v_pk_fma_f32 v[74:75], v[32:33], v[46:47], v[74:75] op_sel:[1,0,0] op_sel_hi:[1,1,1]
    v_cvt_pk_bf16_f32 v72, v72, v73
    v_cvt_pk_bf16_f32 v73, v74, v75
    buffer_store_dwordx2 v[72:73], v156, s[20:23], s43 offen sc1
    v_pk_mul_f32 v[104:105], v[34:35], v[104:105] op_sel_hi:[0,1]
    v_pk_mul_f32 v[106:107], v[34:35], v[106:107] op_sel_hi:[0,1]
    v_pk_fma_f32 v[104:105], v[34:35], v[44:45], v[104:105] op_sel:[1,0,0] op_sel_hi:[1,1,1]
    v_pk_fma_f32 v[106:107], v[34:35], v[46:47], v[106:107] op_sel:[1,0,0] op_sel_hi:[1,1,1]
    v_cvt_pk_bf16_f32 v104, v104, v105
    v_cvt_pk_bf16_f32 v105, v106, v107
    buffer_store_dwordx2 v[104:105], v157, s[20:23], s43 offen sc1
    v_pk_mul_f32 v[76:77], v[32:33], v[76:77] op_sel_hi:[0,1]
    v_pk_mul_f32 v[78:79], v[32:33], v[78:79] op_sel_hi:[0,1]
    v_pk_fma_f32 v[76:77], v[32:33], v[48:49], v[76:77] op_sel:[1,0,0] op_sel_hi:[1,1,1]
    v_pk_fma_f32 v[78:79], v[32:33], v[50:51], v[78:79] op_sel:[1,0,0] op_sel_hi:[1,1,1]
    v_cvt_pk_bf16_f32 v76, v76, v77
    v_cvt_pk_bf16_f32 v77, v78, v79
    buffer_store_dwordx2 v[76:77], v158, s[20:23], s43 offen sc1
    v_pk_mul_f32 v[108:109], v[34:35], v[108:109] op_sel_hi:[0,1]
    v_pk_mul_f32 v[110:111], v[34:35], v[110:111] op_sel_hi:[0,1]
    v_pk_fma_f32 v[108:109], v[34:35], v[48:49], v[108:109] op_sel:[1,0,0] op_sel_hi:[1,1,1]
    v_pk_fma_f32 v[110:111], v[34:35], v[50:51], v[110:111] op_sel:[1,0,0] op_sel_hi:[1,1,1]
    v_cvt_pk_bf16_f32 v108, v108, v109
    v_cvt_pk_bf16_f32 v109, v110, v111
    buffer_store_dwordx2 v[108:109], v159, s[20:23], s43 offen sc1
    v_pk_mul_f32 v[80:81], v[32:33], v[80:81] op_sel_hi:[0,1]
    v_pk_mul_f32 v[82:83], v[32:33], v[82:83] op_sel_hi:[0,1]
    v_pk_fma_f32 v[80:81], v[32:33], v[128:129], v[80:81] op_sel:[1,0,0] op_sel_hi:[1,1,1]
    v_pk_fma_f32 v[82:83], v[32:33], v[130:131], v[82:83] op_sel:[1,0,0] op_sel_hi:[1,1,1]
    v_cvt_pk_bf16_f32 v80, v80, v81
    v_cvt_pk_bf16_f32 v81, v82, v83
    buffer_store_dwordx2 v[80:81], v160, s[20:23], s43 offen sc1
    v_pk_mul_f32 v[112:113], v[34:35], v[112:113] op_sel_hi:[0,1]
    v_pk_mul_f32 v[114:115], v[34:35], v[114:115] op_sel_hi:[0,1]
    v_pk_fma_f32 v[112:113], v[34:35], v[128:129], v[112:113] op_sel:[1,0,0] op_sel_hi:[1,1,1]
    v_pk_fma_f32 v[114:115], v[34:35], v[130:131], v[114:115] op_sel:[1,0,0] op_sel_hi:[1,1,1]
    v_cvt_pk_bf16_f32 v112, v112, v113
    v_cvt_pk_bf16_f32 v113, v114, v115
    buffer_store_dwordx2 v[112:113], v161, s[20:23], s43 offen sc1
    v_pk_mul_f32 v[84:85], v[32:33], v[84:85] op_sel_hi:[0,1]
    v_pk_mul_f32 v[86:87], v[32:33], v[86:87] op_sel_hi:[0,1]
    v_pk_fma_f32 v[84:85], v[32:33], v[132:133], v[84:85] op_sel:[1,0,0] op_sel_hi:[1,1,1]
    v_pk_fma_f32 v[86:87], v[32:33], v[134:135], v[86:87] op_sel:[1,0,0] op_sel_hi:[1,1,1]
    v_cvt_pk_bf16_f32 v84, v84, v85
    v_cvt_pk_bf16_f32 v85, v86, v87
    buffer_store_dwordx2 v[84:85], v162, s[20:23], s43 offen sc1
    v_pk_mul_f32 v[116:117], v[34:35], v[116:117] op_sel_hi:[0,1]
    v_pk_mul_f32 v[118:119], v[34:35], v[118:119] op_sel_hi:[0,1]
    v_pk_fma_f32 v[116:117], v[34:35], v[132:133], v[116:117] op_sel:[1,0,0] op_sel_hi:[1,1,1]
    v_pk_fma_f32 v[118:119], v[34:35], v[134:135], v[118:119] op_sel:[1,0,0] op_sel_hi:[1,1,1]
    v_cvt_pk_bf16_f32 v116, v116, v117
    v_cvt_pk_bf16_f32 v117, v118, v119
    buffer_store_dwordx2 v[116:117], v163, s[20:23], s43 offen sc1
    v_pk_mul_f32 v[88:89], v[32:33], v[88:89] op_sel_hi:[0,1]
    v_pk_mul_f32 v[90:91], v[32:33], v[90:91] op_sel_hi:[0,1]
    v_pk_fma_f32 v[88:89], v[32:33], v[136:137], v[88:89] op_sel:[1,0,0] op_sel_hi:[1,1,1]
    v_pk_fma_f32 v[90:91], v[32:33], v[138:139], v[90:91] op_sel:[1,0,0] op_sel_hi:[1,1,1]
    v_cvt_pk_bf16_f32 v88, v88, v89
    v_cvt_pk_bf16_f32 v89, v90, v91
    buffer_store_dwordx2 v[88:89], v164, s[20:23], s43 offen sc1
    v_pk_mul_f32 v[120:121], v[34:35], v[120:121] op_sel_hi:[0,1]
    v_pk_mul_f32 v[122:123], v[34:35], v[122:123] op_sel_hi:[0,1]
    v_pk_fma_f32 v[120:121], v[34:35], v[136:137], v[120:121] op_sel:[1,0,0] op_sel_hi:[1,1,1]
    v_pk_fma_f32 v[122:123], v[34:35], v[138:139], v[122:123] op_sel:[1,0,0] op_sel_hi:[1,1,1]
    v_cvt_pk_bf16_f32 v120, v120, v121
    v_cvt_pk_bf16_f32 v121, v122, v123
    buffer_store_dwordx2 v[120:121], v165, s[20:23], s43 offen sc1
    v_pk_mul_f32 v[92:93], v[32:33], v[92:93] op_sel_hi:[0,1]
    v_pk_mul_f32 v[94:95], v[32:33], v[94:95] op_sel_hi:[0,1]
    v_pk_fma_f32 v[92:93], v[32:33], v[140:141], v[92:93] op_sel:[1,0,0] op_sel_hi:[1,1,1]
    v_pk_fma_f32 v[94:95], v[32:33], v[142:143], v[94:95] op_sel:[1,0,0] op_sel_hi:[1,1,1]
    v_cvt_pk_bf16_f32 v92, v92, v93
    v_cvt_pk_bf16_f32 v93, v94, v95
    buffer_store_dwordx2 v[92:93], v166, s[20:23], s43 offen sc1
    v_pk_mul_f32 v[124:125], v[34:35], v[124:125] op_sel_hi:[0,1]
    v_pk_mul_f32 v[126:127], v[34:35], v[126:127] op_sel_hi:[0,1]
    v_pk_fma_f32 v[124:125], v[34:35], v[140:141], v[124:125] op_sel:[1,0,0] op_sel_hi:[1,1,1]
    v_pk_fma_f32 v[126:127], v[34:35], v[142:143], v[126:127] op_sel:[1,0,0] op_sel_hi:[1,1,1]
    v_cvt_pk_bf16_f32 v124, v124, v125
    v_cvt_pk_bf16_f32 v125, v126, v127
    buffer_store_dwordx2 v[124:125], v167, s[20:23], s43 offen sc1
    s_branch q1_sync
q1_vloop:
    s_add_u32 s50, s50, 0x8000
    s_and_b32 s50, s50, 0x1ffff
    s_waitcnt lgkmcnt(0)
    v_mfma_f32_32x32x16_bf16 v[64:79], v[32:35], v[40:43], v[64:79]
    ds_read_b128 v[48:51], v9
    ds_read_b128 v[52:55], v13
    ds_read_b64_tr_b16 v[56:57], v16 offset:4096
    v_mfma_f32_32x32x16_bf16 v[80:95], v[32:35], v[44:47], v[80:95]
    ds_read_b64_tr_b16 v[58:59], v16 offset:5120
    ds_read_b64_tr_b16 v[60:61], v17 offset:4096
    ds_read_b64_tr_b16 v[62:63], v17 offset:5120
    v_mfma_f32_32x32x16_bf16 v[96:111], v[36:39], v[40:43], v[96:111]
    v_mfma_f32_32x32x16_bf16 v[112:127], v[36:39], v[44:47], v[112:127]
    s_waitcnt lgkmcnt(0)
    v_mfma_f32_32x32x16_bf16 v[64:79], v[48:51], v[56:59], v[64:79]
    ds_read_b128 v[32:35], v10
    ds_read_b128 v[36:39], v14
    ds_read_b64_tr_b16 v[40:41], v16 offset:8192
    v_mfma_f32_32x32x16_bf16 v[80:95], v[48:51], v[60:63], v[80:95]
    ds_read_b64_tr_b16 v[42:43], v16 offset:9216
    ds_read_b64_tr_b16 v[44:45], v17 offset:8192
    ds_read_b64_tr_b16 v[46:47], v17 offset:9216
    v_mfma_f32_32x32x16_bf16 v[96:111], v[52:55], v[56:59], v[96:111]
    v_mfma_f32_32x32x16_bf16 v[112:127], v[52:55], v[60:63], v[112:127]
    s_waitcnt lgkmcnt(0)
    v_mfma_f32_32x32x16_bf16 v[64:79], v[32:35], v[40:43], v[64:79]
    ds_read_b128 v[48:51], v11
    ds_read_b128 v[52:55], v15
    ds_read_b64_tr_b16 v[56:57], v16 offset:12288
    v_mfma_f32_32x32x16_bf16 v[80:95], v[32:35], v[44:47], v[80:95]
    ds_read_b64_tr_b16 v[58:59], v16 offset:13312
    ds_read_b64_tr_b16 v[60:61], v17 offset:12288
    ds_read_b64_tr_b16 v[62:63], v17 offset:13312
    v_mfma_f32_32x32x16_bf16 v[96:111], v[36:39], v[40:43], v[96:111]
    v_mfma_f32_32x32x16_bf16 v[112:127], v[36:39], v[44:47], v[112:127]
    s_waitcnt lgkmcnt(0)
    v_mfma_f32_32x32x16_bf16 v[64:79], v[48:51], v[56:59], v[64:79]
    v_add_u32 v8, s50, v128
    v_add_u32 v9, s50, v129
    v_add_u32 v10, s50, v130
    v_add_u32 v11, s50, v131
    v_add_u32 v12, s50, v132
    v_mfma_f32_32x32x16_bf16 v[80:95], v[48:51], v[60:63], v[80:95]
    v_add_u32 v13, s50, v133
    v_add_u32 v14, s50, v134
    v_add_u32 v15, s50, v135
    v_add_u32 v16, s50, v136
    v_add_u32 v17, s50, v137
    s_barrier
    ds_read_b128 v[32:35], v8
    ds_read_b128 v[36:39], v12
    ds_read_b64_tr_b16 v[40:41], v16 offset:0
    v_mfma_f32_32x32x16_bf16 v[96:111], v[52:55], v[56:59], v[96:111]
    ds_read_b64_tr_b16 v[42:43], v16 offset:1024
    ds_read_b64_tr_b16 v[44:45], v17 offset:0
    ds_read_b64_tr_b16 v[46:47], v17 offset:1024
    v_mfma_f32_32x32x16_bf16 v[112:127], v[52:55], v[60:63], v[112:127]
    s_sub_u32 s53, s53, 1
    s_cmp_lg_u32 s53, 0
    s_cbranch_scc1 q1_vloop
    s_waitcnt lgkmcnt(0)
    s_waitcnt vmcnt(0)
    v_mov_b32 v25, v145
    v_mov_b32 v26, v148
    v_mul_f32 v24, 0x3acccccd, v144
    s_waitcnt lgkmcnt(0)
    v_mul_f32 v25, 0x3acccccd, v25
    v_fma_f32 v25, -v24, v24, v25
    v_max_f32 v25, 0, v25
    v_add_f32 v25, 0x3727c5ac, v25
    v_rsq_f32 v25, v25
    s_cmp_lt_u32 s25, 5
    s_cselect_b32 s31, 0x3ea52b5c, 1.0
    v_mul_f32 v25, s31, v25
    v_mul_f32 v27, -v24, v25
    s_lshl_b32 s31, s27, 8
    s_lshl_b32 s32, s28, 7
    s_add_u32 s33, s31, s32
    s_add_u32 s33, s33, 0x20000
    v_lshl_add_u32 v28, v18, 2, s33
    ds_write_b32 v28, v25
    ds_write_b32 v28, v27 offset:512
    s_lshl_b32 s31, s28, 8
    s_lshl_b32 s32, s27, 7
    s_add_u32 s37, s31, s32
    s_add_u32 s37, s37, 0x20400
    v_lshl_add_u32 v29, v18, 2, s37
    ds_write_b32 v29, v26
    s_waitcnt lgkmcnt(0)
    s_barrier
    s_lshr_b32 s38, s24, 1
    s_and_b32 s39, s24, 1
    s_lshl_b32 s39, s39, 2
    s_lshl_b32 s31, s27, 1
    s_add_u32 s39, s39, s31
    s_mul_i32 s43, s38, 20480
    s_add_u32 s43, s43, 2631680
    s_add_u32 s39, s39, s28
    s_xor_b32 s45, s39, 1
    s_mul_i32 s39, s39, 1280
    s_mul_i32 s45, s45, 1280
    s_add_u32 s39, s39, s43
    s_add_u32 s45, s45, s43
    v_xor_b32 v30, 128, v29
    ds_read_b32 v32, v29
    ds_read_b32 v33, v30
    v_lshl_add_u32 v31, v19, 4, s33
    v_xor_b32 v30, 128, v31
    s_sub_u32 s31, s25, 10
    s_lshl_b32 s31, s31, 7
    s_lshl_b32 s32, s28, 6
    s_add_u32 s31, s31, s32
    s_lshl_b32 s32, s27, 5
    s_add_u32 s46, s31, s32
    s_xor_b32 s47, s46, 32
    s_mov_b32 s41, 163840
    v_add_u32 v8, s46, v18
    v_mul_u32_u24 v9, 52429, v8
    v_lshrrev_b32 v9, 20, v9
    v_mul_u32_u24 v10, 20, v9
    v_sub_u32 v10, v8, v10
    v_mul_lo_u32 v9, v9, s41
    v_lshl_add_u32 v9, v10, 4, v9
    v_mul_u32_u24 v10, 320, v19
    v_add_u32 v14, v9, v10
    v_add_u32 v8, s47, v18
    v_mul_u32_u24 v9, 52429, v8
    v_lshrrev_b32 v9, 20, v9
    v_mul_u32_u24 v10, 20, v9
    v_sub_u32 v10, v8, v10
    v_mul_lo_u32 v9, v9, s41
    v_lshl_add_u32 v9, v10, 4, v9
    v_mul_u32_u24 v10, 320, v19
    v_add_u32 v15, v9, v10
    ds_read_b128 v[36:39], v31 offset:0
    ds_read_b128 v[128:131], v31 offset:512
    ds_read_b128 v[40:43], v31 offset:32
    ds_read_b128 v[132:135], v31 offset:544
    ds_read_b128 v[44:47], v31 offset:64
    ds_read_b128 v[136:139], v31 offset:576
    ds_read_b128 v[48:51], v31 offset:96
    ds_read_b128 v[140:143], v31 offset:608
    s_waitcnt lgkmcnt(0)
    v_pk_mul_f32 v[64:65], v[36:37], v[64:65]
    v_pk_mul_f32 v[66:67], v[38:39], v[66:67]
    v_pk_mul_f32 v[68:69], v[40:41], v[68:69]
    v_pk_mul_f32 v[70:71], v[42:43], v[70:71]
    v_pk_mul_f32 v[72:73], v[44:45], v[72:73]
    v_pk_mul_f32 v[74:75], v[46:47], v[74:75]
    v_pk_mul_f32 v[76:77], v[48:49], v[76:77]
    v_pk_mul_f32 v[78:79], v[50:51], v[78:79]
    v_pk_fma_f32 v[64:65], v[128:129], v[32:33], v[64:65] op_sel:[0,0,0] op_sel_hi:[1,0,1]
    v_pk_fma_f32 v[66:67], v[130:131], v[32:33], v[66:67] op_sel:[0,0,0] op_sel_hi:[1,0,1]
    v_pk_fma_f32 v[68:69], v[132:133], v[32:33], v[68:69] op_sel:[0,0,0] op_sel_hi:[1,0,1]
    v_pk_fma_f32 v[70:71], v[134:135], v[32:33], v[70:71] op_sel:[0,0,0] op_sel_hi:[1,0,1]
    v_pk_fma_f32 v[72:73], v[136:137], v[32:33], v[72:73] op_sel:[0,0,0] op_sel_hi:[1,0,1]
    v_pk_fma_f32 v[74:75], v[138:139], v[32:33], v[74:75] op_sel:[0,0,0] op_sel_hi:[1,0,1]
    v_pk_fma_f32 v[76:77], v[140:141], v[32:33], v[76:77] op_sel:[0,0,0] op_sel_hi:[1,0,1]
    v_pk_fma_f32 v[78:79], v[142:143], v[32:33], v[78:79] op_sel:[0,0,0] op_sel_hi:[1,0,1]
    v_cvt_pk_bf16_f32 v64, v64, v65
    v_cvt_pk_bf16_f32 v65, v66, v67
    v_cvt_pk_bf16_f32 v66, v68, v69
    v_cvt_pk_bf16_f32 v67, v70, v71
    v_cvt_pk_bf16_f32 v68, v72, v73
    v_cvt_pk_bf16_f32 v69, v74, v75
    v_cvt_pk_bf16_f32 v70, v76, v77
    v_cvt_pk_bf16_f32 v71, v78, v79
    buffer_store_dwordx4 v[64:67], v14, s[20:23], s39 offen sc1
    buffer_store_dwordx4 v[68:71], v14, s[20:23], s39 offen offset:640 sc1
    v_pk_mul_f32 v[80:81], v[36:37], v[80:81]
    v_pk_mul_f32 v[82:83], v[38:39], v[82:83]
    v_pk_mul_f32 v[84:85], v[40:41], v[84:85]
    v_pk_mul_f32 v[86:87], v[42:43], v[86:87]
    v_pk_mul_f32 v[88:89], v[44:45], v[88:89]
    v_pk_mul_f32 v[90:91], v[46:47], v[90:91]
    v_pk_mul_f32 v[92:93], v[48:49], v[92:93]
    v_pk_mul_f32 v[94:95], v[50:51], v[94:95]
    v_pk_fma_f32 v[80:81], v[128:129], v[32:33], v[80:81] op_sel:[0,1,0] op_sel_hi:[1,1,1]
    v_pk_fma_f32 v[82:83], v[130:131], v[32:33], v[82:83] op_sel:[0,1,0] op_sel_hi:[1,1,1]
    v_pk_fma_f32 v[84:85], v[132:133], v[32:33], v[84:85] op_sel:[0,1,0] op_sel_hi:[1,1,1]
    v_pk_fma_f32 v[86:87], v[134:135], v[32:33], v[86:87] op_sel:[0,1,0] op_sel_hi:[1,1,1]
    v_pk_fma_f32 v[88:89], v[136:137], v[32:33], v[88:89] op_sel:[0,1,0] op_sel_hi:[1,1,1]
    v_pk_fma_f32 v[90:91], v[138:139], v[32:33], v[90:91] op_sel:[0,1,0] op_sel_hi:[1,1,1]
    v_pk_fma_f32 v[92:93], v[140:141], v[32:33], v[92:93] op_sel:[0,1,0] op_sel_hi:[1,1,1]
    v_pk_fma_f32 v[94:95], v[142:143], v[32:33], v[94:95] op_sel:[0,1,0] op_sel_hi:[1,1,1]
    v_cvt_pk_bf16_f32 v80, v80, v81
    v_cvt_pk_bf16_f32 v81, v82, v83
    v_cvt_pk_bf16_f32 v82, v84, v85
    v_cvt_pk_bf16_f32 v83, v86, v87
    v_cvt_pk_bf16_f32 v84, v88, v89
    v_cvt_pk_bf16_f32 v85, v90, v91
    v_cvt_pk_bf16_f32 v86, v92, v93
    v_cvt_pk_bf16_f32 v87, v94, v95
    buffer_store_dwordx4 v[80:83], v15, s[20:23], s39 offen sc1
    buffer_store_dwordx4 v[84:87], v15, s[20:23], s39 offen offset:640 sc1
    ds_read_b128 v[36:39], v30 offset:0
    ds_read_b128 v[128:131], v30 offset:512
    ds_read_b128 v[40:43], v30 offset:32
    ds_read_b128 v[132:135], v30 offset:544
    ds_read_b128 v[44:47], v30 offset:64
    ds_read_b128 v[136:139], v30 offset:576
    ds_read_b128 v[48:51], v30 offset:96
    ds_read_b128 v[140:143], v30 offset:608
    s_waitcnt lgkmcnt(0)
    v_pk_mul_f32 v[96:97], v[36:37], v[96:97]
    v_pk_mul_f32 v[98:99], v[38:39], v[98:99]
    v_pk_mul_f32 v[100:101], v[40:41], v[100:101]
    v_pk_mul_f32 v[102:103], v[42:43], v[102:103]
    v_pk_mul_f32 v[104:105], v[44:45], v[104:105]
    v_pk_mul_f32 v[106:107], v[46:47], v[106:107]
    v_pk_mul_f32 v[108:109], v[48:49], v[108:109]
    v_pk_mul_f32 v[110:111], v[50:51], v[110:111]
    v_pk_fma_f32 v[96:97], v[128:129], v[32:33], v[96:97] op_sel:[0,0,0] op_sel_hi:[1,0,1]
    v_pk_fma_f32 v[98:99], v[130:131], v[32:33], v[98:99] op_sel:[0,0,0] op_sel_hi:[1,0,1]
    v_pk_fma_f32 v[100:101], v[132:133], v[32:33], v[100:101] op_sel:[0,0,0] op_sel_hi:[1,0,1]
    v_pk_fma_f32 v[102:103], v[134:135], v[32:33], v[102:103] op_sel:[0,0,0] op_sel_hi:[1,0,1]
    v_pk_fma_f32 v[104:105], v[136:137], v[32:33], v[104:105] op_sel:[0,0,0] op_sel_hi:[1,0,1]
    v_pk_fma_f32 v[106:107], v[138:139], v[32:33], v[106:107] op_sel:[0,0,0] op_sel_hi:[1,0,1]
    v_pk_fma_f32 v[108:109], v[140:141], v[32:33], v[108:109] op_sel:[0,0,0] op_sel_hi:[1,0,1]
    v_pk_fma_f32 v[110:111], v[142:143], v[32:33], v[110:111] op_sel:[0,0,0] op_sel_hi:[1,0,1]
    v_cvt_pk_bf16_f32 v96, v96, v97
    v_cvt_pk_bf16_f32 v97, v98, v99
    v_cvt_pk_bf16_f32 v98, v100, v101
    v_cvt_pk_bf16_f32 v99, v102, v103
    v_cvt_pk_bf16_f32 v100, v104, v105
    v_cvt_pk_bf16_f32 v101, v106, v107
    v_cvt_pk_bf16_f32 v102, v108, v109
    v_cvt_pk_bf16_f32 v103, v110, v111
    buffer_store_dwordx4 v[96:99], v14, s[20:23], s45 offen sc1
    buffer_store_dwordx4 v[100:103], v14, s[20:23], s45 offen offset:640 sc1
    v_pk_mul_f32 v[112:113], v[36:37], v[112:113]
    v_pk_mul_f32 v[114:115], v[38:39], v[114:115]
    v_pk_mul_f32 v[116:117], v[40:41], v[116:117]
    v_pk_mul_f32 v[118:119], v[42:43], v[118:119]
    v_pk_mul_f32 v[120:121], v[44:45], v[120:121]
    v_pk_mul_f32 v[122:123], v[46:47], v[122:123]
    v_pk_mul_f32 v[124:125], v[48:49], v[124:125]
    v_pk_mul_f32 v[126:127], v[50:51], v[126:127]
    v_pk_fma_f32 v[112:113], v[128:129], v[32:33], v[112:113] op_sel:[0,1,0] op_sel_hi:[1,1,1]
    v_pk_fma_f32 v[114:115], v[130:131], v[32:33], v[114:115] op_sel:[0,1,0] op_sel_hi:[1,1,1]
    v_pk_fma_f32 v[116:117], v[132:133], v[32:33], v[116:117] op_sel:[0,1,0] op_sel_hi:[1,1,1]
    v_pk_fma_f32 v[118:119], v[134:135], v[32:33], v[118:119] op_sel:[0,1,0] op_sel_hi:[1,1,1]
    v_pk_fma_f32 v[120:121], v[136:137], v[32:33], v[120:121] op_sel:[0,1,0] op_sel_hi:[1,1,1]
    v_pk_fma_f32 v[122:123], v[138:139], v[32:33], v[122:123] op_sel:[0,1,0] op_sel_hi:[1,1,1]
    v_pk_fma_f32 v[124:125], v[140:141], v[32:33], v[124:125] op_sel:[0,1,0] op_sel_hi:[1,1,1]
    v_pk_fma_f32 v[126:127], v[142:143], v[32:33], v[126:127] op_sel:[0,1,0] op_sel_hi:[1,1,1]
    v_cvt_pk_bf16_f32 v112, v112, v113
    v_cvt_pk_bf16_f32 v113, v114, v115
    v_cvt_pk_bf16_f32 v114, v116, v117
    v_cvt_pk_bf16_f32 v115, v118, v119
    v_cvt_pk_bf16_f32 v116, v120, v121
    v_cvt_pk_bf16_f32 v117, v122, v123
    v_cvt_pk_bf16_f32 v118, v124, v125
    v_cvt_pk_bf16_f32 v119, v126, v127
    buffer_store_dwordx4 v[112:115], v15, s[20:23], s45 offen sc1
    buffer_store_dwordx4 v[116:119], v15, s[20:23], s45 offen offset:640 sc1
q1_sync:
    s_lshl_b32 s31, s60, 17
    s_add_u32 s31, s31, 18644992
    s_bfe_u32 s49, s2, 0x20001
    s_lshl_b32 s49, s49, 2
    s_bfe_u32 s32, s2, 0x20003
    s_add_u32 s49, s49, s32
    s_lshl_b32 s49, s49, 5
    s_and_b32 s51, s2, 1
    s_lshl_b32 s51, s51, 3
    s_lshr_b32 s33, s2, 5
    s_add_u32 s51, s51, s33
    s_lshl_b32 s51, s51, 11
    s_add_u32 s49, s49, s51
    s_and_b32 s51, s2, 7
    s_lshl_b32 s51, s51, 2
    s_add_u32 s51, s51, s32
    s_mul_i32 s32, s51, 20
    s_add_u32 s34, s32, 19
    s_lshr_b32 s32, s32, 7
    s_lshr_b32 s34, s34, 7
    s_sub_u32 s34, s34, s32
    s_lshl_b32 s34, s34, 7
    s_lshl_b32 s51, s32, 11
    s_and_b32 s33, s33, 3
    s_lshl_b32 s33, s33, 9
    s_add_u32 s51, s51, s33
    v_and_b32 v241, 15, v2
    v_lshlrev_b32 v241, 5, v241
    v_and_b32 v9, 16, v2
    v_mul_u32_u24 v9, s34, v9
    v_add_u32 v241, v241, v9
    v_lshrrev_b32 v9, 5, v2
    v_add_u32 v9, 1, v9
    v_mul_u32_u24 v9, 10240, v9
    v_add_u32 v10, v241, v9
    s_add_u32 s49, s49, s31
    s_add_u32 s51, s51, s31
    v_lshlrev_b32 v9, 9, v2
    s_waitcnt vmcnt(0)
    s_barrier
    s_cmp_lg_u32 s26, 0
    s_cbranch_scc1 q1_x_nosig
    v_mov_b32 v4, 1
    s_mov_b64 exec, 0xf
    buffer_store_dword v4, v9, s[12:15], s49 offen sc0 sc1
    s_mov_b64 exec, -1
q1_x_nosig:
    s_cmp_lg_u32 s26, 1
    s_cbranch_scc1 q1_x_np
    s_mov_b32 s92, 65536
    s_mov_b32 exec_lo, 0xffffffff
    s_mov_b32 exec_hi, 0xffffffff
q1_x_pl:
    buffer_load_dword v244, v10, s[12:15], s51 offen sc1
    buffer_load_dword v245, v241, s[12:15], s51 offen sc1
    s_waitcnt vmcnt(0)
    v_and_b32 v244, v244, v245
    v_cmp_eq_u32 vcc, 0, v244
    s_nop 1
    s_cmp_eq_u64 vcc, 0
    s_cbranch_scc1 q1_x_px
    s_sub_u32 s92, s92, 1
    s_cmp_lg_u32 s92, 0
    s_cbranch_scc1 q1_x_pl
q1_x_px:
    s_mov_b64 exec, -1
q1_x_np:
    s_branch att_l1
q1_repack:
    s_barrier
    s_cmp_lt_u32 s26, 4
    s_cbranch_scc1 q1_sync
    s_barrier
    s_branch att_l1
.section .rodata,"a"
.p2align 6
.amdhsa_kernel qkv0_kernel
  .amdhsa_next_free_vgpr 168
  .amdhsa_next_free_sgpr 96
  .amdhsa_accum_offset 168
  .amdhsa_group_segment_fixed_size 0
  .amdhsa_kernarg_size 88
  .amdhsa_user_sgpr_count 2
  .amdhsa_user_sgpr_kernarg_segment_ptr 1
  .amdhsa_system_sgpr_workgroup_id_x 1
.end_amdhsa_kernel
.text
.section .rodata,"a"
.p2align 6
.amdhsa_kernel mega_kernel
  .amdhsa_next_free_vgpr 256
  .amdhsa_next_free_sgpr 96
  .amdhsa_accum_offset 256
  .amdhsa_group_segment_fixed_size 0
  .amdhsa_kernarg_size 88
  .amdhsa_user_sgpr_count 2
  .amdhsa_user_sgpr_kernarg_segment_ptr 1
  .amdhsa_system_sgpr_workgroup_id_x 1
.end_amdhsa_kernel
.text
```
